```python
import torch

def _softmax(x, axis=-1):
    return torch.softmax(x, dim=axis)

def _gelu(x):
    return torch.nn.functional.gelu(x, approximate='tanh')

def _silu(x):
    return torch.nn.functional.silu(x)

def _sigmoid(x):
    return torch.sigmoid(x)

def _layernorm(x, axis=-1, eps=1e-05):
    m = x.mean(dim=axis, keepdim=True)
    v = x.var(dim=axis, keepdim=True, unbiased=False)
    return (x - m) / torch.sqrt(v + eps)

def _scatter_add(tgt, idx, src, axis=0):
    return tgt.clone().index_add_(axis, idx, src)

def _segment_sum(src, seg, n):
    out = torch.zeros((n,) + src.shape[1:], dtype=src.dtype)
    return out.index_add_(0, seg, src)

def _pad(x, pw):
    flat = tuple((v for pair in reversed(pw) for v in pair))
    return torch.nn.functional.pad(x, flat)
kernel_name = 'standalone__video_video_swin__vision'

def setup_inputs():

    _w = lambda a: (lambda t: t.to(torch.bfloat16) if t.is_floating_point() else t)(torch.as_tensor(a))
    T = 4
    H = W = 512 // 7 * 7
    C, win = (96, 7)
    return {'x': _w((lambda *s: torch.randn(*s, dtype=torch.bfloat16) * 0.1)(1, T, H, W, C)), 'wqkv_t': _w((lambda *s: torch.randn(*s, dtype=torch.bfloat16) * 0.1)(C, 3 * C)), 'wo_t': _w((lambda *s: torch.randn(*s, dtype=torch.bfloat16) * 0.1)(C, C)), 'wqkv_s': _w((lambda *s: torch.randn(*s, dtype=torch.bfloat16) * 0.1)(C, 3 * C)), 'wo_s': _w((lambda *s: torch.randn(*s, dtype=torch.bfloat16) * 0.05)(C, C))}

def reference(x, wqkv_t, wo_t, wqkv_s, wo_s):
    B, T, H, W, C = x.shape
    win = 7
    scale = C ** (-0.5)
    h = _layernorm(x, axis=-1)
    ht = (lambda x, *d: x.permute(*d))(h, 0, 2, 3, 1, 4).reshape(B * H * W, T, C)
    qkv = ht @ wqkv_t
    q, k, v = (qkv[..., :C].clone(), qkv[..., C:2 * C].clone(), qkv[..., 2 * C:].clone())
    p = _softmax(torch.einsum('btc,bsc->bts', q, k) * scale, axis=-1)
    ot = torch.einsum('bts,bsc->btc', p, v) @ wo_t
    ot = (lambda x, *d: x.permute(*d))(ot.reshape(B, H, W, T, C), 0, 3, 1, 2, 4)
    x = x + ot
    h = _layernorm(x, axis=-1)
    nh, nw = (H // win, W // win)
    hs = h.reshape(B * T, nh, win, nw, win, C)
    hw = (lambda x, *d: x.permute(*d))(hs, 0, 1, 3, 2, 4, 5).reshape(B * T * nh * nw, win * win, C)
    qkv = hw @ wqkv_s
    q, k, v = (qkv[..., :C].clone(), qkv[..., C:2 * C].clone(), qkv[..., 2 * C:].clone())
    p = _softmax(torch.einsum('bqc,bkc->bqk', q, k) * scale, axis=-1)
    os = torch.einsum('bqk,bkc->bqc', p, v) @ wo_s
    os = (lambda x, *d: x.permute(*d))(os.reshape(B * T, nh, nw, win, win, C), 0, 1, 3, 2, 4, 5)
    os = os.reshape(B, T, H, W, C)
    return x + os
```

```asm
; @launch grid=(256,1,1) block=(512,1,1) lds=160256
.amdgcn_target "amdgcn-amd-amdhsa--gfx950"
.text
.globl standalone__video_video_swin__vision_kernel
.p2align 8
.type standalone__video_video_swin__vision_kernel,@function
standalone__video_video_swin__vision_kernel:
s_cmp_ge_u32 s2, 256
s_cbranch_scc1 L_end
s_load_dwordx2 s[4:5], s[0:1], 0
s_load_dwordx2 s[24:25], s[0:1], 8
s_load_dwordx2 s[26:27], s[0:1], 16
s_load_dwordx2 s[28:29], s[0:1], 24
s_load_dwordx2 s[30:31], s[0:1], 32
s_load_dwordx2 s[8:9], s[0:1], 40
s_load_dwordx2 s[12:13], s[0:1], 56
s_mov_b32 s6, 200540928
s_mov_b32 s7, 0x20000
s_mov_b32 s10, 200540928
s_mov_b32 s11, 0x20000
s_mov_b32 s14, 802163712
s_mov_b32 s15, 0x20000
s_mov_b32 s18, 55296
s_mov_b32 s19, 0x20000
s_mov_b32 s22, 18432
s_mov_b32 s23, 0x20000
v_lshrrev_b32 v20, 6, v0
v_and_b32 v21, 15, v0
v_readfirstlane_b32 s3, v20
v_bfe_u32 v22, v0, 4, 2
v_and_b32 v20, 63, v0
s_and_b32 s57, s3, 3
s_lshr_b32 s58, s3, 2
s_mul_i32 s59, s57, 50135232
v_lshlrev_b32 v23, 4, v22
v_add_u32 v23, s59, v23
s_mov_b32 s60, 98112
v_add_u32 v24, 0, v21
v_mul_u32_u24 v25, 37, v24
v_lshrrev_b32 v25, 8, v25
v_mul_u32_u24 v26, 7, v25
v_sub_u32 v24, v24, v26
v_mul_u32_u24 v24, 192, v24
v_mad_u32_u24 v24, v25, s60, v24
v_add_u32 v0, v24, v23
v_add_u32 v24, 16, v21
v_mul_u32_u24 v25, 37, v24
v_lshrrev_b32 v25, 8, v25
v_mul_u32_u24 v26, 7, v25
v_sub_u32 v24, v24, v26
v_mul_u32_u24 v24, 192, v24
v_mad_u32_u24 v24, v25, s60, v24
v_add_u32 v1, v24, v23
v_add_u32 v24, 32, v21
v_mul_u32_u24 v25, 37, v24
v_lshrrev_b32 v25, 8, v25
v_mul_u32_u24 v26, 7, v25
v_sub_u32 v24, v24, v26
v_mul_u32_u24 v24, 192, v24
v_mad_u32_u24 v24, v25, s60, v24
v_add_u32 v2, v24, v23
v_add_u32 v24, 589824, v23
v_mov_b32 v25, 0x80000000
v_cmp_eq_u32 vcc, 0, v21
s_and_b32 s59, s2, 7
s_lshl_b32 s59, s59, 6
v_cndmask_b32 v3, v25, v24, vcc
s_lshr_b32 s56, s2, 3
s_lshl_b32 s56, s56, 1
s_add_u32 s69, s56, s59
s_add_u32 s56, s69, s58
s_cmp_lt_u32 s2, 209
s_cselect_b32 s59, 1, 0
s_xor_b32 s60, s59, s58
s_andn2_b32 s59, s59, s58
s_add_u32 s49, s59, 10
s_add_u32 s59, s59, 9
s_cmp_eq_u32 s60, 1
s_cselect_b32 s54, s59, -1
s_mul_i32 s53, s58, 37120
s_mul_i32 s59, s57, 9280
s_add_u32 s53, s53, s59
s_add_u32 s53, s53, 73728
s_mov_b32 s55, 0xbc2aaaab
s_mov_b32 s48, -1
s_add_u32 s59, s48, 1
s_lshl_b32 s60, s59, 9
s_add_u32 s60, s60, s56
s_add_u32 s61, s2, 5120
s_cmp_lt_u32 s59, 10
s_cselect_b32 s60, s60, s61
s_mul_i32 s61, s60, 7183
s_lshr_b32 s61, s61, 19
s_mul_i32 s62, s61, 73
s_sub_u32 s60, s60, s62
s_mul_i32 s60, s60, 1344
s_mul_i32 s61, s61, 686784
s_add_u32 s60, s60, s61
s_cmp_lt_u32 s59, s49
s_cselect_b32 s51, s60, 0x40000000
v_lshrrev_b32 v24, 2, v21
v_and_b32 v25, 3, v21
v_lshl_add_u32 v24, v24, 3, v25
v_mul_u32_u24 v252, 576, v24
v_lshl_add_u32 v252, v22, 4, v252
s_and_b32 s37, s3, 1
s_mul_i32 s59, s37, 2304
v_add_u32 v253, s59, v252
s_lshr_b32 s59, s57, 1
s_mul_i32 s59, s59, 36864
s_mul_i32 s60, s58, 18432
s_add_u32 s59, s59, s60
s_mul_i32 s60, s37, 3072
s_add_u32 s59, s59, s60
v_lshl_add_u32 v254, v20, 4, s59
s_lshl_b32 s59, s57, 9
s_add_u32 s59, s59, 148480
v_lshl_add_u32 v255, v22, 4, s59
s_mov_b32 s60, 0
s_mov_b32 s61, 2304
s_mov_b32 s62, 18432
s_mov_b32 s63, 20736
s_mov_b32 s64, 36864
s_mov_b32 s65, 39168
s_mov_b32 s66, 0
s_mov_b32 s67, 6144
s_mov_b32 s68, 12288
s_cmp_lt_u32 s57, 2
s_waitcnt lgkmcnt(0)
s_cselect_b64 s[16:17], s[24:25], s[28:29]
s_cselect_b64 s[20:21], s[26:27], s[30:31]

s_cmp_lg_u32 s58, 0
s_cbranch_scc1 L_g1
buffer_load_dwordx4 v[90:93], v253, s[16:19], s60 offen offset:192
buffer_load_dwordx4 v[94:97], v253, s[16:19], s60 offen offset:256
buffer_load_dwordx4 v[98:101], v253, s[16:19], s60 offen offset:320
buffer_load_dwordx4 v[102:105], v253, s[16:19], s62 offen offset:192
buffer_load_dwordx4 v[106:109], v253, s[16:19], s62 offen offset:256
buffer_load_dwordx4 v[110:113], v253, s[16:19], s62 offen offset:320
buffer_load_dwordx4 v[114:117], v253, s[16:19], s64 offen offset:192
buffer_load_dwordx4 v[118:121], v253, s[16:19], s64 offen offset:256
buffer_load_dwordx4 v[122:125], v253, s[16:19], s64 offen offset:320
buffer_load_dwordx4 v[18:21], v252, s[16:19], s60 offen offset:0
buffer_load_dwordx4 v[22:25], v252, s[16:19], s60 offen offset:64
buffer_load_dwordx4 v[26:29], v252, s[16:19], s60 offen offset:128
buffer_load_dwordx4 v[30:33], v252, s[16:19], s61 offen offset:0
buffer_load_dwordx4 v[34:37], v252, s[16:19], s61 offen offset:64
buffer_load_dwordx4 v[38:41], v252, s[16:19], s61 offen offset:128
buffer_load_dwordx4 v[42:45], v252, s[16:19], s62 offen offset:0
buffer_load_dwordx4 v[46:49], v252, s[16:19], s62 offen offset:64
buffer_load_dwordx4 v[50:53], v252, s[16:19], s62 offen offset:128
buffer_load_dwordx4 v[54:57], v252, s[16:19], s63 offen offset:0
buffer_load_dwordx4 v[58:61], v252, s[16:19], s63 offen offset:64
buffer_load_dwordx4 v[62:65], v252, s[16:19], s63 offen offset:128
buffer_load_dwordx4 v[66:69], v252, s[16:19], s64 offen offset:0
buffer_load_dwordx4 v[70:73], v252, s[16:19], s64 offen offset:64
buffer_load_dwordx4 v[74:77], v252, s[16:19], s64 offen offset:128
buffer_load_dwordx4 v[78:81], v252, s[16:19], s65 offen offset:0
buffer_load_dwordx4 v[82:85], v252, s[16:19], s65 offen offset:64
buffer_load_dwordx4 v[86:89], v252, s[16:19], s65 offen offset:128

v_mbcnt_lo_u32_b32 v226, -1, 0
v_mbcnt_hi_u32_b32 v226, -1, v226
v_and_b32 v227, 15, v226
v_lshrrev_b32 v228, 4, v226
v_lshrrev_b32 v229, 2, v227
v_and_b32 v230, 3, v227
v_cmp_eq_u32 s[40:41], v228, v229
v_cmp_eq_u32 s[42:43], 1, v230
v_cmp_eq_u32 s[44:45], 2, v230
v_cmp_eq_u32 s[46:47], 3, v230
v_lshlrev_b32 v4, 4, v226
v_add_u32 v10, s53, v4
v_add_u32 v4, 36864, v4
v_mul_u32_u24 v231, 9280, v230
v_lshl_add_u32 v231, v228, 8, v231
v_lshl_add_u32 v231, v229, 4, v231
s_mul_i32 s59, s58, 37120
s_add_u32 s59, s59, 73728
s_mul_i32 s60, s57, 12
s_add_u32 s61, s60, 0
s_lshr_b32 s62, s61, 4
s_mul_i32 s62, s62, 3072
s_and_b32 s61, s61, 15
s_lshl_b32 s61, s61, 4
s_add_u32 s61, s61, s62
s_add_u32 s61, s61, s59
v_add_u32 v5, s61, v231
s_add_u32 s61, s60, 4
s_lshr_b32 s62, s61, 4
s_mul_i32 s62, s62, 3072
s_and_b32 s61, s61, 15
s_lshl_b32 s61, s61, 4
s_add_u32 s61, s61, s62
s_add_u32 s61, s61, s59
v_add_u32 v6, s61, v231
s_add_u32 s61, s60, 8
s_lshr_b32 s62, s61, 4
s_mul_i32 s62, s62, 3072
s_and_b32 s61, s61, 15
s_lshl_b32 s61, s61, 4
s_add_u32 s61, s61, s62
s_add_u32 s61, s61, s59
v_add_u32 v7, s61, v231
s_lshl_b32 s59, s58, 11
s_add_u32 s59, s59, 147968
v_lshl_add_u32 v231, v230, 6, v229
v_add_u32 v231, s60, v231
v_lshlrev_b32 v232, 2, v231
v_lshlrev_b32 v233, 1, v231
v_add_u32 v233, 1024, v233
v_lshlrev_b32 v234, 2, v226
v_add_u32 v234, 1536, v234
v_cndmask_b32 v232, v234, v232, s[40:41]
v_cndmask_b32 v233, v234, v233, s[40:41]
v_add_u32 v8, s59, v232
v_add_u32 v9, s59, v233
s_lshl_b32 s60, s57, 8
s_add_u32 s60, s60, s59
v_lshlrev_b32 v14, 4, v228
v_add_u32 v11, s60, v14
v_lshl_add_u32 v249, v227, 10, v14
s_lshl_b32 s36, s3, 10
s_add_u32 s36, s36, 152064
v_min_u32 v231, 1, v230
v_mul_u32_u24 v231, 192, v231
v_add3_u32 v14, v14, v231, s36
v_min_u32 v231, 1, v228
v_lshl_add_u32 v16, v231, 4, s36
v_lshl_add_u32 v15, v227, 2, s36
s_mov_b64 s[38:39], 0xffff
v_lshlrev_b32 v231, 2, v227
v_add_u32 v12, s60, v231
s_lshl_b32 s60, s57, 7
s_add_u32 s60, s60, s59
s_add_u32 s60, s60, 1024
v_lshlrev_b32 v231, 3, v228
v_add_u32 v13, s60, v231
v_xor_b32 v231, 32, v226
v_lshlrev_b32 v17, 2, v231
v_and_b32 v231, 1, v230
v_lshlrev_b32 v231, 4, v231
v_mov_b32 v232, 0x3f80
v_lshlrev_b32 v231, v231, v232
v_cndmask_b32 v231, 0, v231, s[40:41]
v_cmp_gt_u32 vcc, 2, v230
v_mov_b32 v238, 0
v_mov_b32 v239, 0
v_mov_b32 v240, 0
v_mov_b32 v241, 0
v_cndmask_b32 v236, 0, v231, vcc
v_cndmask_b32 v237, v231, 0, vcc
v_mov_b32 v242, v236
v_mov_b32 v243, v237

s_nop 2

s_mov_b32 s59, 0x41622adf
s_waitcnt vmcnt(17)
v_mfma_f32_16x16x32_bf16 v[126:129], v[18:21], v[90:93], 0
v_mfma_f32_16x16x32_bf16 v[150:153], v[18:21], v[102:105], 0
s_waitcnt vmcnt(14)
v_mfma_f32_16x16x32_bf16 v[130:133], v[30:33], v[90:93], 0
v_mfma_f32_16x16x32_bf16 v[154:157], v[30:33], v[102:105], 0
s_waitcnt vmcnt(11)
v_mfma_f32_16x16x32_bf16 v[134:137], v[42:45], v[90:93], 0
v_mfma_f32_16x16x32_bf16 v[158:161], v[42:45], v[102:105], 0
s_waitcnt vmcnt(8)
v_mfma_f32_16x16x32_bf16 v[138:141], v[54:57], v[90:93], 0
v_mfma_f32_16x16x32_bf16 v[162:165], v[54:57], v[102:105], 0
s_waitcnt vmcnt(5)
v_mfma_f32_16x16x32_bf16 v[142:145], v[66:69], v[90:93], 0
v_mfma_f32_16x16x32_bf16 v[166:169], v[66:69], v[102:105], 0
v_mfma_f32_16x16x32_bf16 v[174:177], v[18:21], v[114:117], 0
s_waitcnt vmcnt(2)
v_mfma_f32_16x16x32_bf16 v[146:149], v[78:81], v[90:93], 0
v_mfma_f32_16x16x32_bf16 v[170:173], v[78:81], v[102:105], 0
v_mfma_f32_16x16x32_bf16 v[178:181], v[30:33], v[114:117], 0
v_mfma_f32_16x16x32_bf16 v[182:185], v[42:45], v[114:117], 0
v_mfma_f32_16x16x32_bf16 v[186:189], v[54:57], v[114:117], 0
v_mfma_f32_16x16x32_bf16 v[190:193], v[66:69], v[114:117], 0
v_mfma_f32_16x16x32_bf16 v[194:197], v[78:81], v[114:117], 0
v_mfma_f32_16x16x32_bf16 v[126:129], v[22:25], v[94:97], v[126:129]
v_mfma_f32_16x16x32_bf16 v[150:153], v[22:25], v[106:109], v[150:153]
v_mfma_f32_16x16x32_bf16 v[130:133], v[34:37], v[94:97], v[130:133]
v_mfma_f32_16x16x32_bf16 v[154:157], v[34:37], v[106:109], v[154:157]
v_mfma_f32_16x16x32_bf16 v[134:137], v[46:49], v[94:97], v[134:137]
v_mfma_f32_16x16x32_bf16 v[158:161], v[46:49], v[106:109], v[158:161]
v_mfma_f32_16x16x32_bf16 v[138:141], v[58:61], v[94:97], v[138:141]
v_mfma_f32_16x16x32_bf16 v[162:165], v[58:61], v[106:109], v[162:165]
v_mfma_f32_16x16x32_bf16 v[142:145], v[70:73], v[94:97], v[142:145]
v_mfma_f32_16x16x32_bf16 v[166:169], v[70:73], v[106:109], v[166:169]
v_mfma_f32_16x16x32_bf16 v[174:177], v[22:25], v[118:121], v[174:177]
s_waitcnt vmcnt(1)
v_mfma_f32_16x16x32_bf16 v[146:149], v[82:85], v[94:97], v[146:149]
v_mfma_f32_16x16x32_bf16 v[170:173], v[82:85], v[106:109], v[170:173]
v_mfma_f32_16x16x32_bf16 v[178:181], v[34:37], v[118:121], v[178:181]
v_mfma_f32_16x16x32_bf16 v[182:185], v[46:49], v[118:121], v[182:185]
v_mfma_f32_16x16x32_bf16 v[186:189], v[58:61], v[118:121], v[186:189]
v_mfma_f32_16x16x32_bf16 v[190:193], v[70:73], v[118:121], v[190:193]
s_add_u32 m0, s53, 0
s_nop 0
buffer_load_dwordx4 v0, s[4:7], s51 offen offset:0 nt lds
v_mfma_f32_16x16x32_bf16 v[194:197], v[82:85], v[118:121], v[194:197]
v_mfma_f32_16x16x32_bf16 v[126:129], v[26:29], v[98:101], v[126:129]
v_mfma_f32_16x16x32_bf16 v[150:153], v[26:29], v[110:113], v[150:153]
v_mfma_f32_16x16x32_bf16 v[130:133], v[38:41], v[98:101], v[130:133]
v_mfma_f32_16x16x32_bf16 v[154:157], v[38:41], v[110:113], v[154:157]
s_add_u32 m0, s53, 960
s_nop 0
buffer_load_dwordx4 v0, s[4:7], s51 offen offset:64 nt lds
v_mfma_f32_16x16x32_bf16 v[134:137], v[50:53], v[98:101], v[134:137]
v_mfma_f32_16x16x32_bf16 v[158:161], v[50:53], v[110:113], v[158:161]
v_mfma_f32_16x16x32_bf16 v[138:141], v[62:65], v[98:101], v[138:141]
v_mfma_f32_16x16x32_bf16 v[162:165], v[62:65], v[110:113], v[162:165]
s_add_u32 m0, s53, 1920
s_nop 0
buffer_load_dwordx4 v0, s[4:7], s51 offen offset:128 nt lds
v_mfma_f32_16x16x32_bf16 v[142:145], v[74:77], v[98:101], v[142:145]
v_mfma_f32_16x16x32_bf16 v[166:169], v[74:77], v[110:113], v[166:169]
v_add_f32_e32 v198, v126, v150
v_add_f32_e32 v199, v127, v151
v_mfma_f32_16x16x32_bf16 v[174:177], v[26:29], v[122:125], v[174:177]
v_add_f32_e32 v200, v128, v152
v_add_f32_e32 v201, v129, v153
s_waitcnt vmcnt(3)
v_mfma_f32_16x16x32_bf16 v[146:149], v[86:89], v[98:101], v[146:149]
v_add_f32_e32 v202, v130, v154
v_add_f32_e32 v203, v131, v155
s_add_u32 m0, s53, 3072
s_nop 0
buffer_load_dwordx4 v1, s[4:7], s51 offen offset:0 nt lds
v_mfma_f32_16x16x32_bf16 v[170:173], v[86:89], v[110:113], v[170:173]
v_add_f32_e32 v204, v132, v156
v_add_f32_e32 v205, v133, v157
v_mfma_f32_16x16x32_bf16 v[178:181], v[38:41], v[122:125], v[178:181]
v_add_f32_e32 v206, v134, v158
v_add_f32_e32 v207, v135, v159
v_mfma_f32_16x16x32_bf16 v[182:185], v[50:53], v[122:125], v[182:185]
v_add_f32_e32 v208, v136, v160
v_add_f32_e32 v209, v137, v161
v_mfma_f32_16x16x32_bf16 v[186:189], v[62:65], v[122:125], v[186:189]
v_add_f32_e32 v210, v138, v162
v_add_f32_e32 v211, v139, v163
v_mfma_f32_16x16x32_bf16 v[190:193], v[74:77], v[122:125], v[190:193]
s_add_u32 m0, s53, 4032
s_nop 0
buffer_load_dwordx4 v1, s[4:7], s51 offen offset:64 nt lds
v_add_f32_e32 v212, v140, v164
v_add_f32_e32 v213, v141, v165
v_mfma_f32_16x16x32_bf16 v[194:197], v[86:89], v[122:125], v[194:197]
v_add_f32_e32 v198, v198, v174
v_add_f32_e32 v199, v199, v175
v_add_f32_e32 v200, v200, v176
v_add_f32_e32 v201, v201, v177
v_add_f32_e32 v214, v142, v166
v_add_f32_e32 v215, v143, v167
v_add_f32_e32 v216, v144, v168
v_add_f32_e32 v217, v145, v169
v_add_f32_e32 v202, v202, v178
v_add_f32_e32 v203, v203, v179
v_add_f32_e32 v204, v204, v180
v_add_f32_e32 v205, v205, v181
v_add_f32_e32 v218, v146, v170
s_add_u32 m0, s53, 4992
s_nop 0
buffer_load_dwordx4 v1, s[4:7], s51 offen offset:128 nt lds
v_add_f32_e32 v219, v147, v171
v_add_f32_e32 v220, v148, v172
v_add_f32_e32 v221, v149, v173
v_add_f32_e32 v206, v206, v182
v_add_f32_e32 v207, v207, v183
v_add_f32_e32 v208, v208, v184
v_add_f32_e32 v209, v209, v185
v_add_f32_e32 v210, v210, v186
v_add_f32_e32 v211, v211, v187
v_add_f32_e32 v212, v212, v188
v_add_f32_e32 v213, v213, v189
v_add_f32_dpp v198, v198, v198 row_ror:8 row_mask:0xf bank_mask:0xf
v_add_f32_dpp v199, v199, v199 row_ror:8 row_mask:0xf bank_mask:0xf
v_add_f32_dpp v200, v200, v200 row_ror:8 row_mask:0xf bank_mask:0xf
v_add_f32_dpp v201, v201, v201 row_ror:8 row_mask:0xf bank_mask:0xf
v_add_f32_e32 v214, v214, v190
v_add_f32_e32 v215, v215, v191
s_add_u32 m0, s53, 6144
s_nop 0
buffer_load_dwordx4 v2, s[4:7], s51 offen offset:0 nt lds
v_add_f32_e32 v216, v216, v192
v_add_f32_e32 v217, v217, v193
v_add_f32_dpp v202, v202, v202 row_ror:8 row_mask:0xf bank_mask:0xf
v_add_f32_dpp v203, v203, v203 row_ror:8 row_mask:0xf bank_mask:0xf
v_add_f32_dpp v204, v204, v204 row_ror:8 row_mask:0xf bank_mask:0xf
v_add_f32_dpp v205, v205, v205 row_ror:8 row_mask:0xf bank_mask:0xf
v_add_f32_e32 v218, v218, v194
v_add_f32_e32 v219, v219, v195
v_add_f32_e32 v220, v220, v196
v_add_f32_e32 v221, v221, v197
v_add_f32_dpp v206, v206, v206 row_ror:8 row_mask:0xf bank_mask:0xf
v_add_f32_dpp v207, v207, v207 row_ror:8 row_mask:0xf bank_mask:0xf
v_add_f32_dpp v208, v208, v208 row_ror:8 row_mask:0xf bank_mask:0xf
v_add_f32_dpp v209, v209, v209 row_ror:8 row_mask:0xf bank_mask:0xf
v_add_f32_dpp v210, v210, v210 row_ror:8 row_mask:0xf bank_mask:0xf
v_add_f32_dpp v211, v211, v211 row_ror:8 row_mask:0xf bank_mask:0xf
v_add_f32_dpp v212, v212, v212 row_ror:8 row_mask:0xf bank_mask:0xf
s_add_u32 m0, s53, 7104
s_nop 0
buffer_load_dwordx4 v2, s[4:7], s51 offen offset:64 nt lds
v_add_f32_dpp v213, v213, v213 row_ror:8 row_mask:0xf bank_mask:0xf
v_add_f32_dpp v198, v198, v198 row_ror:4 row_mask:0xf bank_mask:0xf
v_add_f32_dpp v199, v199, v199 row_ror:4 row_mask:0xf bank_mask:0xf
v_add_f32_dpp v200, v200, v200 row_ror:4 row_mask:0xf bank_mask:0xf
v_add_f32_dpp v201, v201, v201 row_ror:4 row_mask:0xf bank_mask:0xf
v_add_f32_dpp v214, v214, v214 row_ror:8 row_mask:0xf bank_mask:0xf
v_add_f32_dpp v215, v215, v215 row_ror:8 row_mask:0xf bank_mask:0xf
v_add_f32_dpp v216, v216, v216 row_ror:8 row_mask:0xf bank_mask:0xf
v_add_f32_dpp v217, v217, v217 row_ror:8 row_mask:0xf bank_mask:0xf
v_add_f32_dpp v202, v202, v202 row_ror:4 row_mask:0xf bank_mask:0xf
v_add_f32_dpp v203, v203, v203 row_ror:4 row_mask:0xf bank_mask:0xf
v_add_f32_dpp v204, v204, v204 row_ror:4 row_mask:0xf bank_mask:0xf
v_add_f32_dpp v205, v205, v205 row_ror:4 row_mask:0xf bank_mask:0xf
v_add_f32_dpp v218, v218, v218 row_ror:8 row_mask:0xf bank_mask:0xf
v_add_f32_dpp v219, v219, v219 row_ror:8 row_mask:0xf bank_mask:0xf
v_add_f32_dpp v220, v220, v220 row_ror:8 row_mask:0xf bank_mask:0xf
v_add_f32_dpp v221, v221, v221 row_ror:8 row_mask:0xf bank_mask:0xf
v_add_f32_dpp v206, v206, v206 row_ror:4 row_mask:0xf bank_mask:0xf
s_add_u32 m0, s53, 8064
s_nop 0
buffer_load_dwordx4 v2, s[4:7], s51 offen offset:128 nt lds
v_add_f32_dpp v207, v207, v207 row_ror:4 row_mask:0xf bank_mask:0xf
v_add_f32_dpp v208, v208, v208 row_ror:4 row_mask:0xf bank_mask:0xf
v_add_f32_dpp v209, v209, v209 row_ror:4 row_mask:0xf bank_mask:0xf
v_add_f32_dpp v210, v210, v210 row_ror:4 row_mask:0xf bank_mask:0xf
v_add_f32_dpp v211, v211, v211 row_ror:4 row_mask:0xf bank_mask:0xf
v_add_f32_dpp v212, v212, v212 row_ror:4 row_mask:0xf bank_mask:0xf
v_add_f32_dpp v213, v213, v213 row_ror:4 row_mask:0xf bank_mask:0xf
v_add_f32_dpp v198, v198, v198 row_ror:2 row_mask:0xf bank_mask:0xf
v_add_f32_dpp v199, v199, v199 row_ror:2 row_mask:0xf bank_mask:0xf
v_add_f32_dpp v200, v200, v200 row_ror:2 row_mask:0xf bank_mask:0xf
v_add_f32_dpp v201, v201, v201 row_ror:2 row_mask:0xf bank_mask:0xf
v_add_f32_dpp v214, v214, v214 row_ror:4 row_mask:0xf bank_mask:0xf
v_add_f32_dpp v215, v215, v215 row_ror:4 row_mask:0xf bank_mask:0xf
v_add_f32_dpp v216, v216, v216 row_ror:4 row_mask:0xf bank_mask:0xf
v_add_f32_dpp v217, v217, v217 row_ror:4 row_mask:0xf bank_mask:0xf
v_add_f32_dpp v202, v202, v202 row_ror:2 row_mask:0xf bank_mask:0xf
v_add_f32_dpp v203, v203, v203 row_ror:2 row_mask:0xf bank_mask:0xf
v_add_f32_dpp v204, v204, v204 row_ror:2 row_mask:0xf bank_mask:0xf
v_add_f32_dpp v205, v205, v205 row_ror:2 row_mask:0xf bank_mask:0xf
v_add_f32_dpp v218, v218, v218 row_ror:4 row_mask:0xf bank_mask:0xf
v_add_f32_dpp v219, v219, v219 row_ror:4 row_mask:0xf bank_mask:0xf
v_add_f32_dpp v220, v220, v220 row_ror:4 row_mask:0xf bank_mask:0xf
v_add_f32_dpp v221, v221, v221 row_ror:4 row_mask:0xf bank_mask:0xf
v_add_f32_dpp v206, v206, v206 row_ror:2 row_mask:0xf bank_mask:0xf
v_add_f32_dpp v207, v207, v207 row_ror:2 row_mask:0xf bank_mask:0xf
v_add_f32_dpp v208, v208, v208 row_ror:2 row_mask:0xf bank_mask:0xf
v_add_f32_dpp v209, v209, v209 row_ror:2 row_mask:0xf bank_mask:0xf
v_add_f32_dpp v210, v210, v210 row_ror:2 row_mask:0xf bank_mask:0xf
v_add_f32_dpp v211, v211, v211 row_ror:2 row_mask:0xf bank_mask:0xf
v_add_f32_dpp v212, v212, v212 row_ror:2 row_mask:0xf bank_mask:0xf
v_add_f32_dpp v213, v213, v213 row_ror:2 row_mask:0xf bank_mask:0xf
v_add_f32_dpp v198, v198, v198 row_ror:1 row_mask:0xf bank_mask:0xf
v_add_f32_dpp v199, v199, v199 row_ror:1 row_mask:0xf bank_mask:0xf
v_add_f32_dpp v200, v200, v200 row_ror:1 row_mask:0xf bank_mask:0xf
v_add_f32_dpp v201, v201, v201 row_ror:1 row_mask:0xf bank_mask:0xf
ds_write_b128 v255, v[198:201] offset:0
v_add_f32_dpp v214, v214, v214 row_ror:2 row_mask:0xf bank_mask:0xf
v_add_f32_dpp v215, v215, v215 row_ror:2 row_mask:0xf bank_mask:0xf
v_add_f32_dpp v216, v216, v216 row_ror:2 row_mask:0xf bank_mask:0xf
v_add_f32_dpp v217, v217, v217 row_ror:2 row_mask:0xf bank_mask:0xf
v_add_f32_dpp v202, v202, v202 row_ror:1 row_mask:0xf bank_mask:0xf
v_add_f32_dpp v203, v203, v203 row_ror:1 row_mask:0xf bank_mask:0xf
v_add_f32_dpp v204, v204, v204 row_ror:1 row_mask:0xf bank_mask:0xf
v_add_f32_dpp v205, v205, v205 row_ror:1 row_mask:0xf bank_mask:0xf
ds_write_b128 v255, v[202:205] offset:64
v_add_f32_dpp v218, v218, v218 row_ror:2 row_mask:0xf bank_mask:0xf
v_add_f32_dpp v219, v219, v219 row_ror:2 row_mask:0xf bank_mask:0xf
v_add_f32_dpp v220, v220, v220 row_ror:2 row_mask:0xf bank_mask:0xf
v_add_f32_dpp v221, v221, v221 row_ror:2 row_mask:0xf bank_mask:0xf
v_add_f32_dpp v206, v206, v206 row_ror:1 row_mask:0xf bank_mask:0xf
v_add_f32_dpp v207, v207, v207 row_ror:1 row_mask:0xf bank_mask:0xf
v_add_f32_dpp v208, v208, v208 row_ror:1 row_mask:0xf bank_mask:0xf
v_add_f32_dpp v209, v209, v209 row_ror:1 row_mask:0xf bank_mask:0xf
ds_write_b128 v255, v[206:209] offset:128
v_add_f32_dpp v210, v210, v210 row_ror:1 row_mask:0xf bank_mask:0xf
v_add_f32_dpp v211, v211, v211 row_ror:1 row_mask:0xf bank_mask:0xf
v_add_f32_dpp v212, v212, v212 row_ror:1 row_mask:0xf bank_mask:0xf
v_add_f32_dpp v213, v213, v213 row_ror:1 row_mask:0xf bank_mask:0xf
ds_write_b128 v255, v[210:213] offset:192
v_add_f32_dpp v214, v214, v214 row_ror:1 row_mask:0xf bank_mask:0xf
v_add_f32_dpp v215, v215, v215 row_ror:1 row_mask:0xf bank_mask:0xf
v_add_f32_dpp v216, v216, v216 row_ror:1 row_mask:0xf bank_mask:0xf
v_add_f32_dpp v217, v217, v217 row_ror:1 row_mask:0xf bank_mask:0xf
ds_write_b128 v255, v[214:217] offset:256
v_add_f32_dpp v218, v218, v218 row_ror:1 row_mask:0xf bank_mask:0xf
v_add_f32_dpp v219, v219, v219 row_ror:1 row_mask:0xf bank_mask:0xf
v_add_f32_dpp v220, v220, v220 row_ror:1 row_mask:0xf bank_mask:0xf
v_add_f32_dpp v221, v221, v221 row_ror:1 row_mask:0xf bank_mask:0xf
ds_write_b128 v255, v[218:221] offset:320
s_waitcnt lgkmcnt(0)
s_barrier
s_nop 0
v_xor_b32_e32 v255, 512, v255
ds_read_b128 v[18:21], v255 offset:0
ds_read_b128 v[22:25], v255 offset:64
ds_read_b128 v[26:29], v255 offset:128
ds_read_b128 v[30:33], v255 offset:192
ds_read_b128 v[34:37], v255 offset:256
ds_read_b128 v[38:41], v255 offset:320
s_waitcnt lgkmcnt(5)
v_add_f32_e32 v198, v198, v18
v_add_f32_e32 v199, v199, v19
v_add_f32_e32 v200, v200, v20
v_add_f32_e32 v201, v201, v21
v_fma_f32 v126, v198, s55, v126
v_fma_f32 v127, v199, s55, v127
v_fma_f32 v128, v200, s55, v128
v_fma_f32 v129, v201, s55, v129
s_waitcnt lgkmcnt(4)
v_add_f32_e32 v202, v202, v22
v_add_f32_e32 v203, v203, v23
v_fma_f32 v150, v198, s55, v150
v_fma_f32 v151, v199, s55, v151
v_fma_f32 v152, v200, s55, v152
v_fma_f32 v153, v201, s55, v153
v_fma_f32 v130, v202, s55, v130
v_fma_f32 v131, v203, s55, v131
v_add_f32_e32 v204, v204, v24
v_add_f32_e32 v205, v205, v25
v_add_f32_e32 v226, v126, v127
v_add_f32_e32 v227, v128, v129
v_fma_f32 v174, v198, s55, v174
v_fma_f32 v175, v199, s55, v175
v_fma_f32 v176, v200, s55, v176
v_fma_f32 v177, v201, s55, v177
v_fma_f32 v154, v202, s55, v154
v_fma_f32 v155, v203, s55, v155
v_add_f32_e32 v228, v150, v151
v_add_f32_e32 v229, v152, v153
v_fma_f32 v132, v204, s55, v132
v_fma_f32 v133, v205, s55, v133
s_waitcnt lgkmcnt(3)
v_add_f32_e32 v206, v206, v26
v_add_f32_e32 v207, v207, v27
v_add_f32_e32 v226, v226, v130
v_add_f32_e32 v227, v227, v131
v_fma_f32 v178, v202, s55, v178
v_fma_f32 v179, v203, s55, v179
v_add_f32_e32 v230, v174, v175
v_add_f32_e32 v231, v176, v177
v_fma_f32 v156, v204, s55, v156
v_fma_f32 v157, v205, s55, v157
v_add_f32_e32 v228, v228, v154
v_add_f32_e32 v229, v229, v155
v_fma_f32 v134, v206, s55, v134
v_fma_f32 v135, v207, s55, v135
v_add_f32_e32 v208, v208, v28
v_add_f32_e32 v209, v209, v29
v_add_f32_e32 v226, v226, v132
v_add_f32_e32 v227, v227, v133
v_fma_f32 v180, v204, s55, v180
v_fma_f32 v181, v205, s55, v181
v_add_f32_e32 v230, v230, v178
v_add_f32_e32 v231, v231, v179
v_fma_f32 v158, v206, s55, v158
v_fma_f32 v159, v207, s55, v159
v_add_f32_e32 v228, v228, v156
v_add_f32_e32 v229, v229, v157
v_fma_f32 v136, v208, s55, v136
v_fma_f32 v137, v209, s55, v137
s_waitcnt lgkmcnt(2)
v_add_f32_e32 v210, v210, v30
v_add_f32_e32 v211, v211, v31
v_add_f32_e32 v226, v226, v134
v_add_f32_e32 v227, v227, v135
v_fma_f32 v182, v206, s55, v182
v_fma_f32 v183, v207, s55, v183
v_add_f32_e32 v230, v230, v180
v_add_f32_e32 v231, v231, v181
v_fma_f32 v160, v208, s55, v160
v_fma_f32 v161, v209, s55, v161
v_add_f32_e32 v228, v228, v158
v_add_f32_e32 v229, v229, v159
v_fma_f32 v138, v210, s55, v138
v_fma_f32 v139, v211, s55, v139
v_add_f32_e32 v212, v212, v32
v_add_f32_e32 v213, v213, v33
v_add_f32_e32 v226, v226, v136
v_add_f32_e32 v227, v227, v137
v_fma_f32 v184, v208, s55, v184
v_fma_f32 v185, v209, s55, v185
v_add_f32_e32 v230, v230, v182
v_add_f32_e32 v231, v231, v183
v_fma_f32 v162, v210, s55, v162
v_fma_f32 v163, v211, s55, v163
v_add_f32_e32 v228, v228, v160
v_add_f32_e32 v229, v229, v161
v_fma_f32 v140, v212, s55, v140
v_fma_f32 v141, v213, s55, v141
s_waitcnt lgkmcnt(1)
v_add_f32_e32 v214, v214, v34
v_add_f32_e32 v215, v215, v35
v_add_f32_e32 v226, v226, v138
v_add_f32_e32 v227, v227, v139
v_fma_f32 v186, v210, s55, v186
v_fma_f32 v187, v211, s55, v187
v_add_f32_e32 v230, v230, v184
v_add_f32_e32 v231, v231, v185
v_fma_f32 v164, v212, s55, v164
v_fma_f32 v165, v213, s55, v165
v_add_f32_e32 v228, v228, v162
v_add_f32_e32 v229, v229, v163
v_fma_f32 v142, v214, s55, v142
v_fma_f32 v143, v215, s55, v143
v_add_f32_e32 v216, v216, v36
v_add_f32_e32 v217, v217, v37
v_add_f32_e32 v226, v226, v140
v_add_f32_e32 v227, v227, v141
v_fma_f32 v188, v212, s55, v188
v_fma_f32 v189, v213, s55, v189
v_add_f32_e32 v230, v230, v186
v_add_f32_e32 v231, v231, v187
v_fma_f32 v166, v214, s55, v166
v_fma_f32 v167, v215, s55, v167
v_add_f32_e32 v228, v228, v164
v_add_f32_e32 v229, v229, v165
v_fma_f32 v144, v216, s55, v144
v_fma_f32 v145, v217, s55, v145
s_waitcnt lgkmcnt(0)
v_add_f32_e32 v218, v218, v38
v_add_f32_e32 v219, v219, v39
v_add_f32_e32 v226, v226, v142
v_add_f32_e32 v227, v227, v143
v_fma_f32 v190, v214, s55, v190
v_fma_f32 v191, v215, s55, v191
v_add_f32_e32 v230, v230, v188
v_add_f32_e32 v231, v231, v189
v_fma_f32 v168, v216, s55, v168
v_fma_f32 v169, v217, s55, v169
v_add_f32_e32 v228, v228, v166
v_add_f32_e32 v229, v229, v167
v_fma_f32 v146, v218, s55, v146
v_fma_f32 v147, v219, s55, v147
v_add_f32_e32 v220, v220, v40
v_add_f32_e32 v221, v221, v41
v_add_f32_e32 v226, v226, v144
v_add_f32_e32 v227, v227, v145
v_fma_f32 v192, v216, s55, v192
v_fma_f32 v193, v217, s55, v193
v_add_f32_e32 v230, v230, v190
v_add_f32_e32 v231, v231, v191
v_fma_f32 v170, v218, s55, v170
v_fma_f32 v171, v219, s55, v171
v_add_f32_e32 v228, v228, v168
v_add_f32_e32 v229, v229, v169
v_fma_f32 v148, v220, s55, v148
v_fma_f32 v149, v221, s55, v149
v_add_f32_e32 v226, v226, v146
v_add_f32_e32 v227, v227, v147
v_fma_f32 v194, v218, s55, v194
v_fma_f32 v195, v219, s55, v195
v_add_f32_e32 v230, v230, v192
v_add_f32_e32 v231, v231, v193
v_fma_f32 v172, v220, s55, v172
v_fma_f32 v173, v221, s55, v173
v_add_f32_e32 v228, v228, v170
v_add_f32_e32 v229, v229, v171
v_add_f32_e32 v226, v226, v148
v_add_f32_e32 v227, v227, v149
v_fma_f32 v196, v220, s55, v196
v_fma_f32 v197, v221, s55, v197
v_add_f32_e32 v230, v230, v194
v_add_f32_e32 v231, v231, v195
v_add_f32_e32 v228, v228, v172
v_add_f32_e32 v229, v229, v173
v_add_f32_e32 v226, v226, v227
v_add_f32_e32 v230, v230, v196
v_add_f32_e32 v231, v231, v197
v_add_f32_e32 v228, v228, v229
v_mov_b32_e32 v227, v226
v_add_f32_e32 v230, v230, v231
v_mov_b32_e32 v229, v228
v_permlane32_swap_b32 v226, v227
v_mov_b32_e32 v231, v230
v_permlane32_swap_b32 v228, v229
v_add_f32_e32 v226, v226, v227
v_permlane32_swap_b32 v230, v231
v_add_f32_e32 v228, v228, v229
v_mov_b32_e32 v227, v226
v_add_f32_e32 v230, v230, v231
v_mov_b32_e32 v229, v228
v_permlane16_swap_b32 v226, v227
v_mov_b32_e32 v231, v230
v_permlane16_swap_b32 v228, v229
v_add_f32_e32 v226, v226, v227
v_permlane16_swap_b32 v230, v231
v_add_f32_e32 v228, v228, v229
v_mul_f32_e32 v226, 0xbe16c73f, v226
v_add_f32_e32 v230, v230, v231
v_mul_f32_e32 v228, 0xbe16c73f, v228
v_fma_f32 v126, v126, s59, v226
v_fma_f32 v127, v127, s59, v226
v_fma_f32 v128, v128, s59, v226
v_fma_f32 v129, v129, s59, v226
v_fma_f32 v134, v134, s59, v226
v_fma_f32 v135, v135, s59, v226
v_fma_f32 v130, v130, s59, v226
v_fma_f32 v131, v131, s59, v226
v_fma_f32 v132, v132, s59, v226
v_fma_f32 v133, v133, s59, v226
v_fma_f32 v136, v136, s59, v226
v_fma_f32 v137, v137, s59, v226
v_fma_f32 v142, v142, s59, v226
v_fma_f32 v143, v143, s59, v226
v_mul_f32_e32 v230, 0xbe16c73f, v230
v_fma_f32 v138, v138, s59, v226
v_fma_f32 v139, v139, s59, v226
v_fma_f32 v140, v140, s59, v226
v_fma_f32 v141, v141, s59, v226
v_fma_f32 v144, v144, s59, v226
v_fma_f32 v145, v145, s59, v226
v_fma_f32 v150, v150, s59, v228
v_fma_f32 v151, v151, s59, v228
v_fma_f32 v146, v146, s59, v226
v_fma_f32 v147, v147, s59, v226
v_fma_f32 v148, v148, s59, v226
v_fma_f32 v149, v149, s59, v226
v_cvt_pk_bf16_f32 v126, v126, v127
v_fma_f32 v152, v152, s59, v228
v_fma_f32 v153, v153, s59, v228
v_fma_f32 v158, v158, s59, v228
v_fma_f32 v159, v159, s59, v228
v_cvt_pk_bf16_f32 v127, v128, v129
v_cvt_pk_bf16_f32 v134, v134, v135
v_fma_f32 v154, v154, s59, v228
v_fma_f32 v155, v155, s59, v228
v_fma_f32 v156, v156, s59, v228
v_fma_f32 v157, v157, s59, v228
v_fma_f32 v160, v160, s59, v228
v_fma_f32 v161, v161, s59, v228
v_fma_f32 v166, v166, s59, v228
v_fma_f32 v167, v167, s59, v228
v_cvt_pk_bf16_f32 v128, v130, v131
v_cvt_pk_bf16_f32 v129, v132, v133
ds_write_b128 v254, v[126:129] offset:0
v_cvt_pk_bf16_f32 v135, v136, v137
v_cvt_pk_bf16_f32 v142, v142, v143
v_fma_f32 v162, v162, s59, v228
v_fma_f32 v163, v163, s59, v228
v_fma_f32 v164, v164, s59, v228
v_fma_f32 v165, v165, s59, v228
v_fma_f32 v168, v168, s59, v228
v_fma_f32 v169, v169, s59, v228
v_fma_f32 v174, v174, s59, v230
v_fma_f32 v175, v175, s59, v230
v_cvt_pk_bf16_f32 v136, v138, v139
v_cvt_pk_bf16_f32 v137, v140, v141
ds_write_b128 v254, v[134:137] offset:1024
v_cvt_pk_bf16_f32 v143, v144, v145
v_fma_f32 v170, v170, s59, v228
v_fma_f32 v171, v171, s59, v228
v_fma_f32 v172, v172, s59, v228
v_fma_f32 v173, v173, s59, v228
v_cvt_pk_bf16_f32 v150, v150, v151
v_fma_f32 v176, v176, s59, v230
v_fma_f32 v177, v177, s59, v230
v_fma_f32 v182, v182, s59, v230
v_fma_f32 v183, v183, s59, v230
v_cvt_pk_bf16_f32 v144, v146, v147
v_cvt_pk_bf16_f32 v145, v148, v149
ds_write_b128 v254, v[142:145] offset:2048
v_cvt_pk_bf16_f32 v151, v152, v153
v_cvt_pk_bf16_f32 v158, v158, v159
v_fma_f32 v178, v178, s59, v230
v_fma_f32 v179, v179, s59, v230
v_fma_f32 v180, v180, s59, v230
v_fma_f32 v181, v181, s59, v230
v_fma_f32 v184, v184, s59, v230
v_fma_f32 v185, v185, s59, v230
v_fma_f32 v190, v190, s59, v230
v_fma_f32 v191, v191, s59, v230
v_cvt_pk_bf16_f32 v152, v154, v155
v_cvt_pk_bf16_f32 v153, v156, v157
ds_write_b128 v254, v[150:153] offset:6144
v_cvt_pk_bf16_f32 v159, v160, v161
v_cvt_pk_bf16_f32 v166, v166, v167
v_fma_f32 v186, v186, s59, v230
v_fma_f32 v187, v187, s59, v230
v_fma_f32 v188, v188, s59, v230
v_fma_f32 v189, v189, s59, v230
v_fma_f32 v192, v192, s59, v230
v_fma_f32 v193, v193, s59, v230
v_cvt_pk_bf16_f32 v160, v162, v163
v_cvt_pk_bf16_f32 v161, v164, v165
ds_write_b128 v254, v[158:161] offset:7168
v_cvt_pk_bf16_f32 v167, v168, v169
v_fma_f32 v194, v194, s59, v230
v_fma_f32 v195, v195, s59, v230
v_fma_f32 v196, v196, s59, v230
v_fma_f32 v197, v197, s59, v230
v_cvt_pk_bf16_f32 v174, v174, v175
v_cvt_pk_bf16_f32 v168, v170, v171
v_cvt_pk_bf16_f32 v169, v172, v173
ds_write_b128 v254, v[166:169] offset:8192
v_cvt_pk_bf16_f32 v175, v176, v177
v_cvt_pk_bf16_f32 v182, v182, v183
v_cvt_pk_bf16_f32 v176, v178, v179
v_cvt_pk_bf16_f32 v177, v180, v181
ds_write_b128 v254, v[174:177] offset:12288
v_cvt_pk_bf16_f32 v183, v184, v185
v_cvt_pk_bf16_f32 v190, v190, v191
v_cvt_pk_bf16_f32 v184, v186, v187
v_cvt_pk_bf16_f32 v185, v188, v189
ds_write_b128 v254, v[182:185] offset:13312
v_cvt_pk_bf16_f32 v191, v192, v193
v_cvt_pk_bf16_f32 v192, v194, v195
v_cvt_pk_bf16_f32 v193, v196, v197
ds_write_b128 v254, v[190:193] offset:14336
s_nop 8
v_lshl_add_u32 v62, v15, 0, s36
v_lshrrev_b32 v62, 1, v62
v_mbcnt_lo_u32_b32 v63, -1, 0
v_mbcnt_hi_u32_b32 v63, -1, v63
v_lshrrev_b32 v63, 4, v63
v_lshl_add_u32 v63, v63, 3, s36

s_branch L_noex
L_g1:
v_mul_u32_u24 v253, 192, v24
v_lshl_add_u32 v253, v22, 4, v253

buffer_load_dwordx4 v[126:129], v253, s[20:23], s66 offen offset:0
buffer_load_dwordx4 v[150:153], v253, s[20:23], s66 offen offset:64
buffer_load_dwordx4 v[174:177], v253, s[20:23], s66 offen offset:128
buffer_load_dwordx4 v[130:133], v253, s[20:23], s66 offen offset:768
buffer_load_dwordx4 v[154:157], v253, s[20:23], s66 offen offset:832
buffer_load_dwordx4 v[178:181], v253, s[20:23], s66 offen offset:896
buffer_load_dwordx4 v[134:137], v253, s[20:23], s67 offen offset:0
buffer_load_dwordx4 v[158:161], v253, s[20:23], s67 offen offset:64
buffer_load_dwordx4 v[182:185], v253, s[20:23], s67 offen offset:128
buffer_load_dwordx4 v[138:141], v253, s[20:23], s67 offen offset:768
buffer_load_dwordx4 v[162:165], v253, s[20:23], s67 offen offset:832
buffer_load_dwordx4 v[186:189], v253, s[20:23], s67 offen offset:896
buffer_load_dwordx4 v[142:145], v253, s[20:23], s68 offen offset:0
buffer_load_dwordx4 v[166:169], v253, s[20:23], s68 offen offset:64
buffer_load_dwordx4 v[190:193], v253, s[20:23], s68 offen offset:128
buffer_load_dwordx4 v[146:149], v253, s[20:23], s68 offen offset:768
buffer_load_dwordx4 v[170:173], v253, s[20:23], s68 offen offset:832
buffer_load_dwordx4 v[194:197], v253, s[20:23], s68 offen offset:896
buffer_load_dwordx4 v[18:21], v252, s[16:19], s60 offen offset:384
buffer_load_dwordx4 v[22:25], v252, s[16:19], s60 offen offset:448
buffer_load_dwordx4 v[26:29], v252, s[16:19], s60 offen offset:512
buffer_load_dwordx4 v[30:33], v252, s[16:19], s61 offen offset:384
buffer_load_dwordx4 v[34:37], v252, s[16:19], s61 offen offset:448
buffer_load_dwordx4 v[38:41], v252, s[16:19], s61 offen offset:512
buffer_load_dwordx4 v[42:45], v252, s[16:19], s62 offen offset:384
buffer_load_dwordx4 v[46:49], v252, s[16:19], s62 offen offset:448
buffer_load_dwordx4 v[50:53], v252, s[16:19], s62 offen offset:512
buffer_load_dwordx4 v[54:57], v252, s[16:19], s63 offen offset:384
buffer_load_dwordx4 v[58:61], v252, s[16:19], s63 offen offset:448
buffer_load_dwordx4 v[62:65], v252, s[16:19], s63 offen offset:512
buffer_load_dwordx4 v[66:69], v252, s[16:19], s64 offen offset:384
buffer_load_dwordx4 v[70:73], v252, s[16:19], s64 offen offset:448
buffer_load_dwordx4 v[74:77], v252, s[16:19], s64 offen offset:512
buffer_load_dwordx4 v[78:81], v252, s[16:19], s65 offen offset:384
buffer_load_dwordx4 v[82:85], v252, s[16:19], s65 offen offset:448
buffer_load_dwordx4 v[86:89], v252, s[16:19], s65 offen offset:512

v_mbcnt_lo_u32_b32 v226, -1, 0
v_mbcnt_hi_u32_b32 v226, -1, v226
v_and_b32 v227, 15, v226
v_lshrrev_b32 v228, 4, v226
v_lshrrev_b32 v229, 2, v227
v_and_b32 v230, 3, v227
v_cmp_eq_u32 s[40:41], v228, v229
v_cmp_eq_u32 s[42:43], 1, v230
v_cmp_eq_u32 s[44:45], 2, v230
v_cmp_eq_u32 s[46:47], 3, v230
v_lshlrev_b32 v4, 4, v226
v_add_u32 v10, s53, v4
v_add_u32 v4, 36864, v4
v_mul_u32_u24 v231, 9280, v230
v_lshl_add_u32 v231, v228, 8, v231
v_lshl_add_u32 v231, v229, 4, v231
s_mul_i32 s59, s58, 37120
s_add_u32 s59, s59, 73728
s_mul_i32 s60, s57, 12
s_add_u32 s61, s60, 0
s_lshr_b32 s62, s61, 4
s_mul_i32 s62, s62, 3072
s_and_b32 s61, s61, 15
s_lshl_b32 s61, s61, 4
s_add_u32 s61, s61, s62
s_add_u32 s61, s61, s59
v_add_u32 v5, s61, v231
s_add_u32 s61, s60, 4
s_lshr_b32 s62, s61, 4
s_mul_i32 s62, s62, 3072
s_and_b32 s61, s61, 15
s_lshl_b32 s61, s61, 4
s_add_u32 s61, s61, s62
s_add_u32 s61, s61, s59
v_add_u32 v6, s61, v231
s_add_u32 s61, s60, 8
s_lshr_b32 s62, s61, 4
s_mul_i32 s62, s62, 3072
s_and_b32 s61, s61, 15
s_lshl_b32 s61, s61, 4
s_add_u32 s61, s61, s62
s_add_u32 s61, s61, s59
v_add_u32 v7, s61, v231
s_lshl_b32 s59, s58, 11
s_add_u32 s59, s59, 147968
v_lshl_add_u32 v231, v230, 6, v229
v_add_u32 v231, s60, v231
v_lshlrev_b32 v232, 2, v231
v_lshlrev_b32 v233, 1, v231
v_add_u32 v233, 1024, v233
v_lshlrev_b32 v234, 2, v226
v_add_u32 v234, 1536, v234
v_cndmask_b32 v232, v234, v232, s[40:41]
v_cndmask_b32 v233, v234, v233, s[40:41]
v_add_u32 v8, s59, v232
v_add_u32 v9, s59, v233
s_lshl_b32 s60, s57, 8
s_add_u32 s60, s60, s59
v_lshlrev_b32 v14, 4, v228
v_add_u32 v11, s60, v14
v_lshl_add_u32 v249, v227, 10, v14
s_lshl_b32 s36, s3, 10
s_add_u32 s36, s36, 152064
v_min_u32 v231, 1, v230
v_mul_u32_u24 v231, 192, v231
v_add3_u32 v14, v14, v231, s36
v_min_u32 v231, 1, v228
v_lshl_add_u32 v16, v231, 4, s36
v_lshl_add_u32 v15, v227, 2, s36
s_mov_b64 s[38:39], 0xffff
v_lshlrev_b32 v231, 2, v227
v_add_u32 v12, s60, v231
s_lshl_b32 s60, s57, 7
s_add_u32 s60, s60, s59
s_add_u32 s60, s60, 1024
v_lshlrev_b32 v231, 3, v228
v_add_u32 v13, s60, v231
v_xor_b32 v231, 32, v226
v_lshlrev_b32 v17, 2, v231
v_and_b32 v231, 1, v230
v_lshlrev_b32 v231, 4, v231
v_mov_b32 v232, 0x3f80
v_lshlrev_b32 v231, v231, v232
v_cndmask_b32 v231, 0, v231, s[40:41]
v_cmp_gt_u32 vcc, 2, v230
v_mov_b32 v238, 0
v_mov_b32 v239, 0
v_mov_b32 v240, 0
v_mov_b32 v241, 0
v_cndmask_b32 v236, 0, v231, vcc
v_cndmask_b32 v237, v231, 0, vcc
v_mov_b32 v242, v236
v_mov_b32 v243, v237

s_lshr_b32 s59, s57, 1
s_add_u32 s59, s59, s69
s_and_b32 s60, s57, 1
s_lshl_b32 s60, s60, 3
s_add_u32 s61, s2, 5120
s_mov_b32 s62, 50135232
v_mul_lo_u32 v234, v230, s62
v_lshl_add_u32 v234, v228, 4, v234
v_add_u32 v234, 589824, v234
s_mov_b32 s62, 686784
v_add_u32 v231, s60, v229
v_add_u32 v231, 0, v231
v_cmp_gt_u32 vcc, 10, v231
v_lshlrev_b32 v231, 9, v231
v_add_u32 v231, s59, v231
v_mov_b32 v232, s61
v_cndmask_b32 v231, v232, v231, vcc
v_min_u32 v231, 5328, v231
v_mul_u32_u24 v232, 7183, v231
v_lshrrev_b32 v232, 19, v232
v_mul_u32_u24 v233, 73, v232
v_sub_u32 v231, v231, v233
v_mul_u32_u24 v231, 1344, v231
v_mad_u32_u24 v231, v232, s62, v231
v_add_u32 v247, v231, v234
v_add_u32 v231, s60, v229
v_add_u32 v231, 4, v231
v_cmp_gt_u32 vcc, 10, v231
v_lshlrev_b32 v231, 9, v231
v_add_u32 v231, s59, v231
v_mov_b32 v232, s61
v_cndmask_b32 v231, v232, v231, vcc
v_min_u32 v231, 5328, v231
v_mul_u32_u24 v232, 7183, v231
v_lshrrev_b32 v232, 19, v232
v_mul_u32_u24 v233, 73, v232
v_sub_u32 v231, v231, v233
v_mul_u32_u24 v231, 1344, v231
v_mad_u32_u24 v231, v232, s62, v231
v_add_u32 v248, v231, v234
v_lshlrev_b32 v231, 10, v227
v_lshl_add_u32 v233, v228, 2, v229
v_lshlrev_b32 v233, 4, v233
v_lshl_add_u32 v233, v230, 8, v233
v_add_u32 v250, 36864, v233
v_mov_b32 v232, 0x80000000
v_cndmask_b32 v251, v232, v231, s[40:41]
s_nop 0
s_lshr_b32 s59, s57, 1
s_sub_u32 s59, 3, s59
s_cmp_eq_u32 s37, 1
s_cselect_b32 s59, s59, 4
v_cmp_gt_u32 vcc, s59, v229
s_nop 1
v_cndmask_b32 v251, v232, v251, vcc
v_cndmask_b32 v249, v232, v249, vcc
v_cndmask_b32 v247, v232, v247, vcc
s_cselect_b64 vcc, 0, -1
s_nop 1
v_cndmask_b32 v248, v232, v248, vcc
s_nop 0

s_add_u32 m0, s53, 0
s_nop 0
buffer_load_dwordx4 v247, s[4:7], 0 offen offset:0 lds
s_add_u32 m0, s53, 960
s_nop 0
buffer_load_dwordx4 v247, s[4:7], 0 offen offset:64 lds
s_add_u32 m0, s53, 1920
s_nop 0
buffer_load_dwordx4 v247, s[4:7], 0 offen offset:128 lds
s_add_u32 m0, s53, 3072
s_nop 0
buffer_load_dwordx4 v248, s[4:7], 0 offen offset:0 lds
s_add_u32 m0, s53, 4032
s_nop 0
buffer_load_dwordx4 v248, s[4:7], 0 offen offset:64 lds
s_add_u32 m0, s53, 4992
s_nop 0
buffer_load_dwordx4 v248, s[4:7], 0 offen offset:128 lds
s_cmp_eq_u32 s37, 0
s_cselect_b64 vcc, -1, 0
v_cndmask_b32 v222, v240, v236, vcc
v_cndmask_b32 v223, v241, v237, vcc
v_cndmask_b32 v224, v242, v238, vcc
v_cndmask_b32 v225, v243, v239, vcc
s_nop 2

s_mov_b32 s59, 0x411cc471
s_waitcnt vmcnt(41)
v_mfma_f32_16x16x32_bf16 v[198:201], v[126:129], v[222:225], 0
s_waitcnt vmcnt(38)
v_mfma_f32_16x16x32_bf16 v[202:205], v[130:133], v[222:225], 0
s_waitcnt vmcnt(35)
v_mfma_f32_16x16x32_bf16 v[206:209], v[134:137], v[222:225], 0
s_waitcnt vmcnt(32)
v_mfma_f32_16x16x32_bf16 v[210:213], v[138:141], v[222:225], 0
s_waitcnt vmcnt(29)
v_mfma_f32_16x16x32_bf16 v[214:217], v[142:145], v[222:225], 0
s_waitcnt vmcnt(26)
v_mfma_f32_16x16x32_bf16 v[218:221], v[146:149], v[222:225], 0
v_cvt_pk_bf16_f32 v90, v198, v199
v_cvt_pk_bf16_f32 v91, v200, v201
v_mfma_f32_16x16x32_bf16 v[198:201], v[150:153], v[222:225], 0
v_cvt_pk_bf16_f32 v92, v202, v203
v_cvt_pk_bf16_f32 v93, v204, v205
v_mfma_f32_16x16x32_bf16 v[202:205], v[154:157], v[222:225], 0
v_cvt_pk_bf16_f32 v94, v206, v207
v_cvt_pk_bf16_f32 v95, v208, v209
v_mfma_f32_16x16x32_bf16 v[206:209], v[158:161], v[222:225], 0
v_cvt_pk_bf16_f32 v96, v210, v211
v_cvt_pk_bf16_f32 v97, v212, v213
v_mfma_f32_16x16x32_bf16 v[210:213], v[162:165], v[222:225], 0
v_cvt_pk_bf16_f32 v102, v198, v199
v_cvt_pk_bf16_f32 v103, v200, v201
v_mfma_f32_16x16x32_bf16 v[198:201], v[174:177], v[222:225], 0
v_cvt_pk_bf16_f32 v104, v202, v203
v_cvt_pk_bf16_f32 v105, v204, v205
v_mfma_f32_16x16x32_bf16 v[202:205], v[178:181], v[222:225], 0
v_cvt_pk_bf16_f32 v98, v214, v215
v_cvt_pk_bf16_f32 v99, v216, v217
v_mfma_f32_16x16x32_bf16 v[214:217], v[166:169], v[222:225], 0
v_cvt_pk_bf16_f32 v100, v218, v219
v_cvt_pk_bf16_f32 v101, v220, v221
s_waitcnt vmcnt(25)
v_mfma_f32_16x16x32_bf16 v[218:221], v[170:173], v[222:225], 0
v_cvt_pk_bf16_f32 v106, v206, v207
v_cvt_pk_bf16_f32 v107, v208, v209
v_mfma_f32_16x16x32_bf16 v[206:209], v[182:185], v[222:225], 0
v_cvt_pk_bf16_f32 v108, v210, v211
v_cvt_pk_bf16_f32 v109, v212, v213
v_mfma_f32_16x16x32_bf16 v[210:213], v[186:189], v[222:225], 0
v_cvt_pk_bf16_f32 v114, v198, v199
v_cvt_pk_bf16_f32 v115, v200, v201
s_waitcnt vmcnt(23)
v_mfma_f32_16x16x32_bf16 v[126:129], v[18:21], v[90:93], 0
v_cvt_pk_bf16_f32 v116, v202, v203
v_cvt_pk_bf16_f32 v117, v204, v205
v_mfma_f32_16x16x32_bf16 v[150:153], v[18:21], v[102:105], 0
v_cvt_pk_bf16_f32 v110, v214, v215
v_cvt_pk_bf16_f32 v111, v216, v217
v_mfma_f32_16x16x32_bf16 v[214:217], v[190:193], v[222:225], 0
v_cvt_pk_bf16_f32 v112, v218, v219
v_cvt_pk_bf16_f32 v113, v220, v221
v_mfma_f32_16x16x32_bf16 v[218:221], v[194:197], v[222:225], 0
v_cvt_pk_bf16_f32 v118, v206, v207
v_cvt_pk_bf16_f32 v119, v208, v209
s_waitcnt vmcnt(20)
v_mfma_f32_16x16x32_bf16 v[130:133], v[30:33], v[90:93], 0
v_cvt_pk_bf16_f32 v120, v210, v211
v_cvt_pk_bf16_f32 v121, v212, v213
v_mfma_f32_16x16x32_bf16 v[174:177], v[18:21], v[114:117], 0
v_cvt_pk_bf16_f32 v122, v214, v215
v_cvt_pk_bf16_f32 v123, v216, v217
v_mfma_f32_16x16x32_bf16 v[154:157], v[30:33], v[102:105], 0
v_cvt_pk_bf16_f32 v124, v218, v219
v_cvt_pk_bf16_f32 v125, v220, v221
v_mfma_f32_16x16x32_bf16 v[178:181], v[30:33], v[114:117], 0
s_waitcnt vmcnt(17)
v_mfma_f32_16x16x32_bf16 v[134:137], v[42:45], v[90:93], 0
v_mfma_f32_16x16x32_bf16 v[158:161], v[42:45], v[102:105], 0
v_mfma_f32_16x16x32_bf16 v[126:129], v[22:25], v[94:97], v[126:129]
v_mfma_f32_16x16x32_bf16 v[182:185], v[42:45], v[114:117], 0
v_mfma_f32_16x16x32_bf16 v[150:153], v[22:25], v[106:109], v[150:153]
s_waitcnt vmcnt(14)
v_mfma_f32_16x16x32_bf16 v[138:141], v[54:57], v[90:93], 0
v_mfma_f32_16x16x32_bf16 v[130:133], v[34:37], v[94:97], v[130:133]
v_mfma_f32_16x16x32_bf16 v[174:177], v[22:25], v[118:121], v[174:177]
v_mfma_f32_16x16x32_bf16 v[162:165], v[54:57], v[102:105], 0
v_mfma_f32_16x16x32_bf16 v[154:157], v[34:37], v[106:109], v[154:157]
v_mfma_f32_16x16x32_bf16 v[186:189], v[54:57], v[114:117], 0
v_mfma_f32_16x16x32_bf16 v[178:181], v[34:37], v[118:121], v[178:181]
s_waitcnt vmcnt(11)
v_mfma_f32_16x16x32_bf16 v[142:145], v[66:69], v[90:93], 0
v_mfma_f32_16x16x32_bf16 v[134:137], v[46:49], v[94:97], v[134:137]
v_mfma_f32_16x16x32_bf16 v[166:169], v[66:69], v[102:105], 0
v_mfma_f32_16x16x32_bf16 v[158:161], v[46:49], v[106:109], v[158:161]
v_mfma_f32_16x16x32_bf16 v[126:129], v[26:29], v[98:101], v[126:129]
v_mfma_f32_16x16x32_bf16 v[190:193], v[66:69], v[114:117], 0
v_mfma_f32_16x16x32_bf16 v[182:185], v[46:49], v[118:121], v[182:185]
v_mfma_f32_16x16x32_bf16 v[150:153], v[26:29], v[110:113], v[150:153]
s_waitcnt vmcnt(8)
v_mfma_f32_16x16x32_bf16 v[146:149], v[78:81], v[90:93], 0
v_mfma_f32_16x16x32_bf16 v[138:141], v[58:61], v[94:97], v[138:141]
v_mfma_f32_16x16x32_bf16 v[130:133], v[38:41], v[98:101], v[130:133]
v_mfma_f32_16x16x32_bf16 v[174:177], v[26:29], v[122:125], v[174:177]
v_mfma_f32_16x16x32_bf16 v[170:173], v[78:81], v[102:105], 0
v_add_f32_e32 v226, v126, v127
v_add_f32_e32 v227, v128, v129
v_mfma_f32_16x16x32_bf16 v[162:165], v[58:61], v[106:109], v[162:165]
v_add_f32_e32 v228, v150, v151
v_add_f32_e32 v229, v152, v153
v_mfma_f32_16x16x32_bf16 v[154:157], v[38:41], v[110:113], v[154:157]
v_add_f32_e32 v226, v226, v130
v_add_f32_e32 v227, v227, v131
v_mfma_f32_16x16x32_bf16 v[194:197], v[78:81], v[114:117], 0
v_add_f32_e32 v230, v174, v175
v_add_f32_e32 v231, v176, v177
v_mfma_f32_16x16x32_bf16 v[186:189], v[58:61], v[118:121], v[186:189]
v_add_f32_e32 v226, v226, v132
v_add_f32_e32 v227, v227, v133
v_mfma_f32_16x16x32_bf16 v[178:181], v[38:41], v[122:125], v[178:181]
v_add_f32_e32 v228, v228, v154
v_add_f32_e32 v229, v229, v155
v_mfma_f32_16x16x32_bf16 v[142:145], v[70:73], v[94:97], v[142:145]
v_add_f32_e32 v228, v228, v156
v_add_f32_e32 v229, v229, v157
v_mfma_f32_16x16x32_bf16 v[134:137], v[50:53], v[98:101], v[134:137]
v_mfma_f32_16x16x32_bf16 v[166:169], v[70:73], v[106:109], v[166:169]
v_mfma_f32_16x16x32_bf16 v[158:161], v[50:53], v[110:113], v[158:161]
s_barrier
v_add_f32_e32 v230, v230, v178
v_add_f32_e32 v231, v231, v179
v_mfma_f32_16x16x32_bf16 v[190:193], v[70:73], v[118:121], v[190:193]
v_add_f32_e32 v230, v230, v180
v_add_f32_e32 v231, v231, v181
v_mfma_f32_16x16x32_bf16 v[182:185], v[50:53], v[122:125], v[182:185]
v_add_f32_e32 v226, v226, v134
v_add_f32_e32 v227, v227, v135
s_waitcnt vmcnt(7)
v_mfma_f32_16x16x32_bf16 v[146:149], v[82:85], v[94:97], v[146:149]
v_add_f32_e32 v228, v228, v158
v_add_f32_e32 v229, v229, v159
v_mfma_f32_16x16x32_bf16 v[138:141], v[62:65], v[98:101], v[138:141]
v_add_f32_e32 v226, v226, v136
v_add_f32_e32 v227, v227, v137
v_mfma_f32_16x16x32_bf16 v[170:173], v[82:85], v[106:109], v[170:173]
v_add_f32_e32 v230, v230, v182
v_add_f32_e32 v231, v231, v183
v_mfma_f32_16x16x32_bf16 v[162:165], v[62:65], v[110:113], v[162:165]
v_add_f32_e32 v228, v228, v160
v_add_f32_e32 v229, v229, v161
v_mfma_f32_16x16x32_bf16 v[194:197], v[82:85], v[118:121], v[194:197]
v_add_f32_e32 v226, v226, v138
v_add_f32_e32 v227, v227, v139
v_mfma_f32_16x16x32_bf16 v[186:189], v[62:65], v[122:125], v[186:189]
v_add_f32_e32 v230, v230, v184
v_add_f32_e32 v231, v231, v185
v_mfma_f32_16x16x32_bf16 v[142:145], v[74:77], v[98:101], v[142:145]
v_add_f32_e32 v228, v228, v162
v_add_f32_e32 v229, v229, v163
v_mfma_f32_16x16x32_bf16 v[166:169], v[74:77], v[110:113], v[166:169]
v_add_f32_e32 v226, v226, v140
v_add_f32_e32 v227, v227, v141
v_mfma_f32_16x16x32_bf16 v[190:193], v[74:77], v[122:125], v[190:193]
v_add_f32_e32 v230, v230, v186
v_add_f32_e32 v231, v231, v187
s_waitcnt vmcnt(6)
v_mfma_f32_16x16x32_bf16 v[146:149], v[86:89], v[98:101], v[146:149]
v_add_f32_e32 v228, v228, v164
v_add_f32_e32 v229, v229, v165
v_mfma_f32_16x16x32_bf16 v[170:173], v[86:89], v[110:113], v[170:173]
v_add_f32_e32 v226, v226, v142
v_add_f32_e32 v227, v227, v143
v_mfma_f32_16x16x32_bf16 v[194:197], v[86:89], v[122:125], v[194:197]
v_add_f32_e32 v230, v230, v188
v_add_f32_e32 v231, v231, v189
v_add_f32_e32 v228, v228, v166
v_add_f32_e32 v229, v229, v167
v_add_f32_e32 v226, v226, v144
v_add_f32_e32 v227, v227, v145
v_add_f32_e32 v230, v230, v190
v_add_f32_e32 v231, v231, v191
v_add_f32_e32 v228, v228, v168
v_add_f32_e32 v229, v229, v169
v_add_f32_e32 v226, v226, v146
v_add_f32_e32 v227, v227, v147
v_add_f32_e32 v230, v230, v192
v_add_f32_e32 v231, v231, v193
v_add_f32_e32 v228, v228, v170
v_add_f32_e32 v229, v229, v171
v_add_f32_e32 v226, v226, v148
v_add_f32_e32 v227, v227, v149
v_add_f32_e32 v230, v230, v194
v_add_f32_e32 v231, v231, v195
v_add_f32_e32 v228, v228, v172
v_add_f32_e32 v229, v229, v173
v_add_f32_e32 v226, v226, v227
v_add_f32_e32 v230, v230, v196
v_add_f32_e32 v231, v231, v197
v_add_f32_e32 v228, v228, v229
v_mov_b32_e32 v227, v226
v_add_f32_e32 v230, v230, v231
v_mov_b32_e32 v229, v228
v_permlane32_swap_b32 v226, v227
v_mov_b32_e32 v231, v230
v_permlane32_swap_b32 v228, v229
v_add_f32_e32 v226, v226, v227
v_permlane32_swap_b32 v230, v231
v_add_f32_e32 v228, v228, v229
v_mov_b32_e32 v227, v226
v_add_f32_e32 v230, v230, v231
v_mov_b32_e32 v229, v228
v_permlane16_swap_b32 v226, v227
v_mov_b32_e32 v231, v230
v_permlane16_swap_b32 v228, v229
v_add_f32_e32 v226, v226, v227
v_permlane16_swap_b32 v230, v231
v_add_f32_e32 v228, v228, v229
v_mul_f32_e32 v226, 0xbdd105ec, v226
v_add_f32_e32 v230, v230, v231
v_mul_f32_e32 v228, 0xbdd105ec, v228
v_fma_f32 v126, v126, s59, v226
v_fma_f32 v127, v127, s59, v226
v_fma_f32 v128, v128, s59, v226
v_fma_f32 v129, v129, s59, v226
v_fma_f32 v134, v134, s59, v226
v_fma_f32 v135, v135, s59, v226
v_fma_f32 v130, v130, s59, v226
v_fma_f32 v131, v131, s59, v226
v_fma_f32 v132, v132, s59, v226
v_fma_f32 v133, v133, s59, v226
v_fma_f32 v136, v136, s59, v226
v_fma_f32 v137, v137, s59, v226
v_fma_f32 v142, v142, s59, v226
v_fma_f32 v143, v143, s59, v226
v_mul_f32_e32 v230, 0xbdd105ec, v230
v_fma_f32 v138, v138, s59, v226
v_fma_f32 v139, v139, s59, v226
v_fma_f32 v140, v140, s59, v226
v_fma_f32 v141, v141, s59, v226
v_fma_f32 v144, v144, s59, v226
v_fma_f32 v145, v145, s59, v226
v_fma_f32 v150, v150, s59, v228
v_fma_f32 v151, v151, s59, v228
v_fma_f32 v146, v146, s59, v226
v_fma_f32 v147, v147, s59, v226
v_fma_f32 v148, v148, s59, v226
v_fma_f32 v149, v149, s59, v226
v_cvt_pk_bf16_f32 v126, v126, v127
v_fma_f32 v152, v152, s59, v228
v_fma_f32 v153, v153, s59, v228
v_fma_f32 v158, v158, s59, v228
v_fma_f32 v159, v159, s59, v228
v_cvt_pk_bf16_f32 v127, v128, v129
v_cvt_pk_bf16_f32 v134, v134, v135
v_fma_f32 v154, v154, s59, v228
v_fma_f32 v155, v155, s59, v228
v_fma_f32 v156, v156, s59, v228
v_fma_f32 v157, v157, s59, v228
v_fma_f32 v160, v160, s59, v228
v_fma_f32 v161, v161, s59, v228
v_fma_f32 v166, v166, s59, v228
v_fma_f32 v167, v167, s59, v228
v_cvt_pk_bf16_f32 v128, v130, v131
v_cvt_pk_bf16_f32 v129, v132, v133
ds_write_b128 v254, v[126:129] offset:0
v_cvt_pk_bf16_f32 v135, v136, v137
v_cvt_pk_bf16_f32 v142, v142, v143
v_fma_f32 v162, v162, s59, v228
v_fma_f32 v163, v163, s59, v228
v_fma_f32 v164, v164, s59, v228
v_fma_f32 v165, v165, s59, v228
v_fma_f32 v168, v168, s59, v228
v_fma_f32 v169, v169, s59, v228
v_fma_f32 v174, v174, s59, v230
v_fma_f32 v175, v175, s59, v230
v_cvt_pk_bf16_f32 v136, v138, v139
v_cvt_pk_bf16_f32 v137, v140, v141
ds_write_b128 v254, v[134:137] offset:1024
v_cvt_pk_bf16_f32 v143, v144, v145
v_fma_f32 v170, v170, s59, v228
v_fma_f32 v171, v171, s59, v228
v_fma_f32 v172, v172, s59, v228
v_fma_f32 v173, v173, s59, v228
v_cvt_pk_bf16_f32 v150, v150, v151
v_fma_f32 v176, v176, s59, v230
v_fma_f32 v177, v177, s59, v230
v_fma_f32 v182, v182, s59, v230
v_fma_f32 v183, v183, s59, v230
v_cvt_pk_bf16_f32 v144, v146, v147
v_cvt_pk_bf16_f32 v145, v148, v149
ds_write_b128 v254, v[142:145] offset:2048
v_cvt_pk_bf16_f32 v151, v152, v153
v_cvt_pk_bf16_f32 v158, v158, v159
v_fma_f32 v178, v178, s59, v230
v_fma_f32 v179, v179, s59, v230
v_fma_f32 v180, v180, s59, v230
v_fma_f32 v181, v181, s59, v230
v_fma_f32 v184, v184, s59, v230
v_fma_f32 v185, v185, s59, v230
v_fma_f32 v190, v190, s59, v230
v_fma_f32 v191, v191, s59, v230
v_cvt_pk_bf16_f32 v152, v154, v155
v_cvt_pk_bf16_f32 v153, v156, v157
ds_write_b128 v254, v[150:153] offset:6144
v_cvt_pk_bf16_f32 v159, v160, v161
v_cvt_pk_bf16_f32 v166, v166, v167
v_fma_f32 v186, v186, s59, v230
v_fma_f32 v187, v187, s59, v230
v_fma_f32 v188, v188, s59, v230
v_fma_f32 v189, v189, s59, v230
v_fma_f32 v192, v192, s59, v230
v_fma_f32 v193, v193, s59, v230
v_cvt_pk_bf16_f32 v160, v162, v163
v_cvt_pk_bf16_f32 v161, v164, v165
ds_write_b128 v254, v[158:161] offset:7168
v_cvt_pk_bf16_f32 v167, v168, v169
v_fma_f32 v194, v194, s59, v230
v_fma_f32 v195, v195, s59, v230
v_fma_f32 v196, v196, s59, v230
v_fma_f32 v197, v197, s59, v230
v_cvt_pk_bf16_f32 v174, v174, v175
v_cvt_pk_bf16_f32 v168, v170, v171
v_cvt_pk_bf16_f32 v169, v172, v173
ds_write_b128 v254, v[166:169] offset:8192
v_cvt_pk_bf16_f32 v175, v176, v177
v_cvt_pk_bf16_f32 v182, v182, v183
v_cvt_pk_bf16_f32 v176, v178, v179
v_cvt_pk_bf16_f32 v177, v180, v181
ds_write_b128 v254, v[174:177] offset:12288
v_cvt_pk_bf16_f32 v183, v184, v185
v_cvt_pk_bf16_f32 v190, v190, v191
v_cvt_pk_bf16_f32 v184, v186, v187
v_cvt_pk_bf16_f32 v185, v188, v189
ds_write_b128 v254, v[182:185] offset:13312
v_cvt_pk_bf16_f32 v191, v192, v193
v_cvt_pk_bf16_f32 v192, v194, v195
v_cvt_pk_bf16_f32 v193, v196, v197
ds_write_b128 v254, v[190:193] offset:14336
s_nop 8
v_lshl_add_u32 v62, v15, 0, s36
v_lshrrev_b32 v62, 1, v62
v_mbcnt_lo_u32_b32 v63, -1, 0
v_mbcnt_hi_u32_b32 v63, -1, v63
v_lshrrev_b32 v63, 4, v63
v_lshl_add_u32 v63, v63, 3, s36
s_lshl_b32 s60, s2, 17
s_add_u32 s60, s60, 40960
s_lshl_b32 s61, s57, 15
s_add_u32 s60, s60, s61
s_add_u32 s61, s60, 16384
s_mov_b32 s62, 0x05040100
s_mov_b32 s63, 0x07060302
s_waitcnt vmcnt(0) lgkmcnt(0)
s_barrier
s_setprio 3

ds_read_b128 v[18:21], v10 offset:0
v_subrev_u32_e32 v218, 36864, v4
v_mov_b32_e32 v214, 0x3f803f80
v_mov_b32_e32 v215, 0x3f803f80
v_mov_b32_e32 v216, 0x3f803f80
ds_read_b128 v[30:33], v10 offset:3072
v_mov_b32_e32 v217, 0x3f803f80
ds_read_b128 v[170:173], v218 offset:0
ds_read_b128 v[22:25], v10 offset:1024
ds_read_b128 v[34:37], v10 offset:4096
ds_read_b128 v[174:177], v218 offset:1024
s_waitcnt lgkmcnt(5)
v_lshlrev_b32_e32 v54, 16, v18
v_and_b32_e32 v55, 0xffff0000, v18
ds_read_b128 v[182:185], v218 offset:3072
v_lshlrev_b32_e32 v56, 16, v19
v_and_b32_e32 v57, 0xffff0000, v19
v_lshlrev_b32_e32 v58, 16, v20
v_and_b32_e32 v59, 0xffff0000, v20
ds_read_b128 v[26:29], v10 offset:2048
v_lshlrev_b32_e32 v60, 16, v21
v_and_b32_e32 v61, 0xffff0000, v21
s_waitcnt lgkmcnt(5)
v_mfma_f32_16x16x32_bf16 v[190:193], v[170:173], v[18:21], 0
ds_read_b128 v[38:41], v10 offset:5120
v_lshlrev_b32_e32 v166, 16, v30
v_mfma_f32_16x16x32_bf16 v[194:197], v[170:173], v[30:33], 0
ds_read_b128 v[178:181], v218 offset:2048
s_waitcnt lgkmcnt(6)
v_lshlrev_b32_e32 v150, 16, v22
v_and_b32_e32 v151, 0xffff0000, v22
v_lshlrev_b32_e32 v152, 16, v23
v_and_b32_e32 v153, 0xffff0000, v23
ds_read_b128 v[186:189], v218 offset:4096
v_lshlrev_b32_e32 v154, 16, v24
s_waitcnt lgkmcnt(5)
v_mfma_f32_16x16x32_bf16 v[190:193], v[174:177], v[22:25], v[190:193]
v_and_b32_e32 v155, 0xffff0000, v24
ds_read_b128 v[46:49], v218 offset:6144
v_mfma_f32_16x16x32_bf16 v[194:197], v[174:177], v[34:37], v[194:197]
v_lshlrev_b32_e32 v156, 16, v25
ds_read_b128 v[42:45], v218 offset:5120
s_waitcnt lgkmcnt(6)
v_mfma_f32_16x16x32_bf16 v[198:201], v[182:185], v[18:21], 0
s_waitcnt lgkmcnt(4)
s_add_u32 m0, s53, 0
s_nop 0
buffer_load_dwordx4 v0, s[4:7], s51 offen offset:0 nt lds
v_and_b32_e32 v157, 0xffff0000, v25
ds_read_b128 v[50:53], v218 offset:7168
v_mfma_f32_16x16x32_bf16 v[202:205], v[182:185], v[30:33], 0
v_lshlrev_b32_e32 v158, 16, v26
ds_read_b128 v[90:93], v218 offset:8192
v_and_b32_e32 v159, 0xffff0000, v26
s_waitcnt lgkmcnt(5)
v_mfma_f32_16x16x32_bf16 v[190:193], v[178:181], v[26:29], v[190:193]
v_lshlrev_b32_e32 v160, 16, v27
ds_read_b128 v[94:97], v218 offset:9216
v_mfma_f32_16x16x32_bf16 v[194:197], v[178:181], v[38:41], v[194:197]
v_and_b32_e32 v161, 0xffff0000, v27
ds_read_b128 v[142:145], v218 offset:12288
s_waitcnt lgkmcnt(6)
v_mfma_f32_16x16x32_bf16 v[198:201], v[186:189], v[22:25], v[198:201]
v_lshlrev_b32_e32 v162, 16, v28
ds_read_b128 v[98:101], v218 offset:10240
s_waitcnt lgkmcnt(6)
v_mfma_f32_16x16x32_bf16 v[206:209], v[46:49], v[18:21], 0
v_cvt_pk_bf16_f32 v66, v190, v191
ds_read_b128 v[146:149], v218 offset:13312
v_mfma_f32_16x16x32_bf16 v[210:213], v[46:49], v[30:33], 0
v_cvt_pk_bf16_f32 v67, v192, v193
ds_read_b128 v[174:177], v218 offset:15360
s_waitcnt lgkmcnt(7)
v_mfma_f32_16x16x32_bf16 v[198:201], v[42:45], v[26:29], v[198:201]
v_cvt_pk_bf16_f32 v78, v194, v195
ds_read_b128 v[138:141], v218 offset:11264
s_add_u32 m0, s53, 960
s_nop 0
buffer_load_dwordx4 v0, s[4:7], s51 offen offset:64 nt lds
s_waitcnt lgkmcnt(7)
v_mfma_f32_16x16x32_bf16 v[206:209], v[50:53], v[22:25], v[206:209]
v_cvt_pk_bf16_f32 v79, v196, v197
ds_read_b128 v[170:173], v218 offset:14336
v_mfma_f32_16x16x32_bf16 v[210:213], v[50:53], v[34:37], v[210:213]
v_and_b32_e32 v163, 0xffff0000, v28
ds_read_b128 v[178:181], v218 offset:16384
s_waitcnt lgkmcnt(8)
v_mfma_f32_16x16x32_bf16 v[206:209], v[90:93], v[26:29], v[206:209]
v_cvt_pk_bf16_f32 v68, v198, v199
ds_read_b128 v[182:185], v218 offset:17408
v_mfma_f32_16x16x32_bf16 v[210:213], v[90:93], v[38:41], v[210:213]
v_cvt_pk_bf16_f32 v69, v200, v201
ds_read_b128 v[46:49], v218 offset:20480
v_mfma_f32_16x16x32_bf16 v[202:205], v[186:189], v[34:37], v[202:205]
v_lshlrev_b32_e32 v164, 16, v29
ds_read_b128 v[186:189], v218 offset:18432
s_waitcnt lgkmcnt(10)
v_mfma_f32_16x16x32_bf16 v[190:193], v[94:97], v[18:21], 0
v_cvt_pk_bf16_f32 v70, v206, v207
ds_read_b128 v[50:53], v218 offset:21504
s_waitcnt lgkmcnt(10)
v_mfma_f32_16x16x32_bf16 v[198:201], v[142:145], v[18:21], 0
v_cvt_pk_bf16_f32 v71, v208, v209
ds_read_b128 v[90:93], v218 offset:22528
v_mfma_f32_16x16x32_bf16 v[194:197], v[94:97], v[30:33], 0
v_cvt_pk_bf16_f32 v82, v210, v211
s_add_u32 m0, s53, 1920
s_nop 0
buffer_load_dwordx4 v0, s[4:7], s51 offen offset:128 nt lds
ds_read_b128 v[94:97], v218 offset:23552
v_mfma_f32_16x16x32_bf16 v[202:205], v[42:45], v[38:41], v[202:205]
v_cvt_pk_bf16_f32 v83, v212, v213
ds_read_b128 v[42:45], v218 offset:19456
s_waitcnt lgkmcnt(12)
v_mfma_f32_16x16x32_bf16 v[190:193], v[98:101], v[22:25], v[190:193]
v_and_b32_e32 v165, 0xffff0000, v29
v_and_b32_e32 v167, 0xffff0000, v30
s_waitcnt lgkmcnt(11)
v_mfma_f32_16x16x32_bf16 v[198:201], v[146:149], v[22:25], v[198:201]
v_lshlrev_b32_e32 v168, 16, v31
v_and_b32_e32 v169, 0xffff0000, v31
s_waitcnt lgkmcnt(10)
v_mfma_f32_16x16x32_bf16 v[206:209], v[174:177], v[18:21], 0
v_cvt_pk_bf16_f32 v80, v202, v203
v_cvt_pk_bf16_f32 v81, v204, v205
v_mfma_f32_16x16x32_bf16 v[210:213], v[174:177], v[30:33], 0
ds_read_b128 v[174:177], v218 offset:29696
v_mfma_f32_16x16x32_bf16 v[194:197], v[98:101], v[34:37], v[194:197]
ds_read_b128 v[98:101], v218 offset:24576
s_waitcnt lgkmcnt(11)
v_mfma_f32_16x16x32_bf16 v[190:193], v[138:141], v[26:29], v[190:193]
s_waitcnt lgkmcnt(10)
v_mfma_f32_16x16x32_bf16 v[198:201], v[170:173], v[26:29], v[198:201]
s_add_u32 m0, s53, 3072
s_nop 0
buffer_load_dwordx4 v1, s[4:7], s51 offen offset:0 nt lds
s_waitcnt lgkmcnt(9)
v_mfma_f32_16x16x32_bf16 v[206:209], v[178:181], v[22:25], v[206:209]
v_mfma_f32_16x16x32_bf16 v[210:213], v[178:181], v[34:37], v[210:213]
ds_read_b128 v[178:181], v218 offset:30720
v_mfma_f32_16x16x32_bf16 v[194:197], v[138:141], v[38:41], v[194:197]
ds_read_b128 v[138:141], v218 offset:25600
s_waitcnt lgkmcnt(10)
v_mfma_f32_16x16x32_bf16 v[206:209], v[182:185], v[26:29], v[206:209]
v_mfma_f32_16x16x32_bf16 v[210:213], v[182:185], v[38:41], v[210:213]
ds_read_b128 v[182:185], v218 offset:31744
v_cvt_pk_bf16_f32 v72, v190, v191
v_mfma_f32_16x16x32_bf16 v[202:205], v[142:145], v[30:33], 0
ds_read_b128 v[142:145], v218 offset:26624
v_cvt_pk_bf16_f32 v73, v192, v193
v_mfma_f32_16x16x32_bf16 v[190:193], v[18:21], v[18:21], 0
v_cvt_pk_bf16_f32 v74, v198, v199
v_cvt_pk_bf16_f32 v75, v200, v201
v_mfma_f32_16x16x32_bf16 v[198:201], v[30:33], v[30:33], 0
s_add_u32 m0, s53, 4032
s_nop 0
buffer_load_dwordx4 v1, s[4:7], s51 offen offset:64 nt lds
v_cvt_pk_bf16_f32 v84, v194, v195
v_cvt_pk_bf16_f32 v85, v196, v197
v_mfma_f32_16x16x32_bf16 v[194:197], v[214:217], v[18:21], 0
v_cvt_pk_bf16_f32 v76, v206, v207
v_cvt_pk_bf16_f32 v77, v208, v209
v_mfma_f32_16x16x32_bf16 v[190:193], v[22:25], v[22:25], v[190:193]
v_cvt_pk_bf16_f32 v88, v210, v211
v_cvt_pk_bf16_f32 v89, v212, v213
v_mfma_f32_16x16x32_bf16 v[198:201], v[34:37], v[34:37], v[198:201]
v_mfma_f32_16x16x32_bf16 v[202:205], v[146:149], v[34:37], v[202:205]
ds_read_b128 v[146:149], v218 offset:27648
s_waitcnt lgkmcnt(11)
v_mfma_f32_16x16x32_bf16 v[206:209], v[18:21], v[186:189], 0
v_mfma_f32_16x16x32_bf16 v[210:213], v[30:33], v[186:189], 0
ds_read_b128 v[186:189], v218 offset:32768
v_mfma_f32_16x16x32_bf16 v[194:197], v[214:217], v[22:25], v[194:197]
v_mfma_f32_16x16x32_bf16 v[190:193], v[26:29], v[26:29], v[190:193]
s_add_u32 m0, s53, 4992
s_nop 0
buffer_load_dwordx4 v1, s[4:7], s51 offen offset:128 nt lds
v_mfma_f32_16x16x32_bf16 v[198:201], v[38:41], v[38:41], v[198:201]
v_mfma_f32_16x16x32_bf16 v[202:205], v[170:173], v[38:41], v[202:205]
ds_read_b128 v[170:173], v218 offset:28672
s_waitcnt lgkmcnt(9)
v_mfma_f32_16x16x32_bf16 v[206:209], v[22:25], v[42:45], v[206:209]
v_mfma_f32_16x16x32_bf16 v[210:213], v[34:37], v[42:45], v[210:213]
ds_read_b128 v[42:45], v218 offset:33792
v_mfma_f32_16x16x32_bf16 v[194:197], v[214:217], v[26:29], v[194:197]
v_mfma_f32_16x16x32_bf16 v[102:105], v[18:21], v[66:69], 0
v_cndmask_b32_e64 v222, v190, v191, s[42:43]
v_cndmask_b32_e64 v223, v198, v199, s[42:43]
v_mfma_f32_16x16x32_bf16 v[206:209], v[26:29], v[46:49], v[206:209]
v_cndmask_b32_e64 v222, v222, v192, s[44:45]
v_cndmask_b32_e64 v223, v223, v200, s[44:45]
v_mfma_f32_16x16x32_bf16 v[210:213], v[38:41], v[46:49], v[210:213]
s_add_u32 m0, s53, 6144
s_nop 0
buffer_load_dwordx4 v2, s[4:7], s51 offen offset:0 nt lds
ds_read_b128 v[46:49], v218 offset:34816
v_cndmask_b32_e64 v222, v222, v193, s[46:47]
v_mfma_f32_16x16x32_bf16 v[102:105], v[22:25], v[70:73], v[102:105]
v_cndmask_b32_e64 v223, v223, v201, s[46:47]
v_mul_f32_e32 v219, v194, v194
v_mfma_f32_16x16x32_bf16 v[190:193], v[18:21], v[50:53], 0
v_cvt_pk_bf16_f32 v86, v202, v203
v_cvt_pk_bf16_f32 v87, v204, v205
s_waitcnt lgkmcnt(9)
v_mfma_f32_16x16x32_bf16 v[198:201], v[18:21], v[98:101], 0
v_fma_f32 v222, v219, s55, v222
v_max_f32_e32 v222, 0, v222
v_mfma_f32_16x16x32_bf16 v[194:197], v[30:33], v[50:53], 0
ds_read_b128 v[50:53], v218 offset:35840
v_add_f32_e32 v222, 0x3a7ba882, v222
v_mfma_f32_16x16x32_bf16 v[102:105], v[26:29], v[74:77], v[102:105]
v_rsq_f32_e32 v219, v222
v_mfma_f32_16x16x32_bf16 v[202:205], v[214:217], v[30:33], 0
v_cvt_pk_bf16_f32 v114, v206, v207
v_cvt_pk_bf16_f32 v115, v208, v209
v_mfma_f32_16x16x32_bf16 v[190:193], v[22:25], v[90:93], v[190:193]
v_cvt_pk_bf16_f32 v126, v210, v211
v_cvt_pk_bf16_f32 v127, v212, v213
s_add_u32 m0, s53, 7104
s_nop 0
buffer_load_dwordx4 v2, s[4:7], s51 offen offset:64 nt lds
s_waitcnt lgkmcnt(8)
v_mfma_f32_16x16x32_bf16 v[198:201], v[22:25], v[138:141], v[198:201]
v_mul_f32_dpp v102, v219, v102 quad_perm:[0,0,0,0] row_mask:0xf bank_mask:0xf
v_mul_f32_dpp v103, v219, v103 quad_perm:[1,1,1,1] row_mask:0xf bank_mask:0xf
v_mfma_f32_16x16x32_bf16 v[202:205], v[214:217], v[34:37], v[202:205]
v_mul_f32_dpp v104, v219, v104 quad_perm:[2,2,2,2] row_mask:0xf bank_mask:0xf
v_mul_f32_dpp v105, v219, v105 quad_perm:[3,3,3,3] row_mask:0xf bank_mask:0xf
v_mfma_f32_16x16x32_bf16 v[190:193], v[26:29], v[94:97], v[190:193]
v_max3_f32 v222, v102, v103, v104
v_max_f32_e32 v222, v222, v105
s_waitcnt lgkmcnt(6)
v_mfma_f32_16x16x32_bf16 v[198:201], v[26:29], v[142:145], v[198:201]
v_mul_f32_e64 v222, -v222, v219
v_fma_f32 v102, v102, v219, v222
v_mfma_f32_16x16x32_bf16 v[202:205], v[214:217], v[38:41], v[202:205]
v_fma_f32 v103, v103, v219, v222
v_fma_f32 v104, v104, v219, v222
s_waitcnt lgkmcnt(5)
v_mfma_f32_16x16x32_bf16 v[206:209], v[18:21], v[146:149], 0
v_fma_f32 v105, v105, v219, v222
v_exp_f32_e32 v102, v102
v_mfma_f32_16x16x32_bf16 v[106:109], v[30:33], v[78:81], 0
v_exp_f32_e32 v103, v103
s_waitcnt lgkmcnt(3)
v_mfma_f32_16x16x32_bf16 v[206:209], v[22:25], v[170:173], v[206:209]
s_add_u32 m0, s53, 8064
s_nop 0
buffer_load_dwordx4 v2, s[4:7], s51 offen offset:128 nt lds
v_exp_f32_e32 v104, v104
v_mfma_f32_16x16x32_bf16 v[106:109], v[34:37], v[82:85], v[106:109]
v_exp_f32_e32 v105, v105
v_mfma_f32_16x16x32_bf16 v[194:197], v[34:37], v[90:93], v[194:197]
ds_read_b128 v[90:93], v4 offset:0
v_cvt_pk_bf16_f32 v116, v190, v191
v_mfma_f32_16x16x32_bf16 v[206:209], v[26:29], v[174:177], v[206:209]
v_cvt_pk_bf16_f32 v117, v192, v193
v_cvt_pk_bf16_f32 v118, v198, v199
v_mfma_f32_16x16x32_bf16 v[190:193], v[18:21], v[178:181], 0
v_cvt_pk_bf16_f32 v119, v200, v201
v_add_f32_e32 v222, v102, v103
s_waitcnt lgkmcnt(3)
v_mfma_f32_16x16x32_bf16 v[198:201], v[18:21], v[42:45], 0
v_add_f32_e32 v225, v104, v105
v_add_f32_e32 v225, v225, v222
v_mfma_f32_16x16x32_bf16 v[190:193], v[22:25], v[182:185], v[190:193]
v_mul_f32_e32 v220, v202, v202
v_rcp_f32_e32 v225, v225
v_mfma_f32_16x16x32_bf16 v[202:205], v[30:33], v[98:101], 0
ds_read_b128 v[98:101], v4 offset:2048
v_mul_f32_dpp v102, v219, v102 quad_perm:[0,0,0,0] row_mask:0xf bank_mask:0xf
s_waitcnt lgkmcnt(3)
v_mfma_f32_16x16x32_bf16 v[198:201], v[22:25], v[46:49], v[198:201]
v_mul_f32_dpp v103, v219, v103 quad_perm:[1,1,1,1] row_mask:0xf bank_mask:0xf
v_mul_f32_dpp v104, v219, v104 quad_perm:[2,2,2,2] row_mask:0xf bank_mask:0xf
v_mfma_f32_16x16x32_bf16 v[210:213], v[30:33], v[146:149], 0
ds_read_b128 v[146:149], v4 offset:5120
v_mul_f32_dpp v105, v219, v105 quad_perm:[3,3,3,3] row_mask:0xf bank_mask:0xf
v_mfma_f32_16x16x32_bf16 v[106:109], v[38:41], v[86:89], v[106:109]
v_mul_f32_e32 v102, v102, v225
v_mul_f32_e32 v103, v103, v225
v_mfma_f32_16x16x32_bf16 v[194:197], v[38:41], v[94:97], v[194:197]
ds_read_b128 v[94:97], v4 offset:1024
v_mul_f32_e32 v104, v104, v225
v_mfma_f32_16x16x32_bf16 v[202:205], v[34:37], v[138:141], v[202:205]
ds_read_b128 v[138:141], v4 offset:3072
v_mul_f32_e32 v105, v105, v225
v_mfma_f32_16x16x32_bf16 v[190:193], v[26:29], v[186:189], v[190:193]
v_cvt_pk_bf16_f32 v102, v102, v103
v_cvt_pk_bf16_f32 v103, v104, v105
s_waitcnt lgkmcnt(5)
v_mfma_f32_16x16x32_bf16 v[198:201], v[26:29], v[50:53], v[198:201]
v_cndmask_b32_e64 v102, 0, v102, s[40:41]
v_cndmask_b32_e64 v103, 0, v103, s[40:41]
v_mfma_f32_16x16x32_bf16 v[210:213], v[34:37], v[170:173], v[210:213]
ds_read_b128 v[170:173], v4 offset:6144
v_fma_f32 v223, v220, s55, v223
v_mfma_f32_16x16x16_bf16 v[54:57], v[114:115], v[102:103], v[54:57]
v_max_f32_e32 v223, 0, v223
v_add_f32_e32 v223, 0x3a7ba882, v223
v_rsq_f32_e32 v220, v223
v_mfma_f32_16x16x16_bf16 v[58:61], v[116:117], v[102:103], v[58:61]
v_cvt_pk_bf16_f32 v120, v206, v207
v_cvt_pk_bf16_f32 v121, v208, v209
v_mul_f32_dpp v106, v220, v106 quad_perm:[0,0,0,0] row_mask:0xf bank_mask:0xf
v_mfma_f32_16x16x32_bf16 v[202:205], v[38:41], v[142:145], v[202:205]
ds_read_b128 v[142:145], v4 offset:4096
v_mul_f32_dpp v107, v220, v107 quad_perm:[1,1,1,1] row_mask:0xf bank_mask:0xf
v_mfma_f32_16x16x16_bf16 v[150:153], v[118:119], v[102:103], v[150:153]
v_mul_f32_dpp v108, v220, v108 quad_perm:[2,2,2,2] row_mask:0xf bank_mask:0xf
v_mul_f32_dpp v109, v220, v109 quad_perm:[3,3,3,3] row_mask:0xf bank_mask:0xf
v_max3_f32 v223, v106, v107, v108
v_mfma_f32_16x16x16_bf16 v[154:157], v[120:121], v[102:103], v[154:157]
v_cvt_pk_bf16_f32 v128, v194, v195
v_cvt_pk_bf16_f32 v129, v196, v197
v_cvt_pk_bf16_f32 v122, v190, v191
v_mfma_f32_16x16x32_bf16 v[210:213], v[38:41], v[174:177], v[210:213]
ds_read_b128 v[174:177], v4 offset:7168
v_cvt_pk_bf16_f32 v123, v192, v193
v_mfma_f32_16x16x32_bf16 v[194:197], v[30:33], v[178:181], 0
ds_read_b128 v[178:181], v4 offset:8192
v_cvt_pk_bf16_f32 v124, v198, v199
v_mfma_f32_16x16x16_bf16 v[158:161], v[122:123], v[102:103], v[158:161]
v_cvt_pk_bf16_f32 v125, v200, v201
v_max_f32_e32 v223, v223, v109
v_cvt_pk_bf16_f32 v66, v54, v55
v_mfma_f32_16x16x16_bf16 v[162:165], v[124:125], v[102:103], v[162:165]
v_cvt_pk_bf16_f32 v67, v56, v57
v_cvt_pk_bf16_f32 v68, v58, v59
v_cvt_pk_bf16_f32 v69, v60, v61
v_mfma_f32_16x16x32_bf16 v[194:197], v[34:37], v[182:185], v[194:197]
ds_read_b128 v[182:185], v4 offset:9216
v_mul_f32_e64 v223, -v223, v220
v_mfma_f32_16x16x32_bf16 v[206:209], v[66:69], v[66:69], 0
v_fma_f32 v106, v106, v220, v223
v_fma_f32 v107, v107, v220, v223
v_mfma_f32_16x16x32_bf16 v[194:197], v[38:41], v[186:189], v[194:197]
ds_read_b128 v[186:189], v4 offset:10240
v_fma_f32 v108, v108, v220, v223
v_fma_f32 v109, v109, v220, v223
v_exp_f32_e32 v106, v106
v_exp_f32_e32 v107, v107
v_exp_f32_e32 v108, v108
v_exp_f32_e32 v109, v109
v_cvt_pk_bf16_f32 v130, v202, v203
v_cvt_pk_bf16_f32 v131, v204, v205
v_mfma_f32_16x16x32_bf16 v[202:205], v[30:33], v[42:45], 0
ds_read_b128 v[42:45], v4 offset:11264
v_cvt_pk_bf16_f32 v70, v150, v151
v_cvt_pk_bf16_f32 v71, v152, v153
v_mfma_f32_16x16x32_bf16 v[202:205], v[34:37], v[46:49], v[202:205]
ds_read_b128 v[46:49], v4 offset:12288
v_cvt_pk_bf16_f32 v72, v154, v155
v_cvt_pk_bf16_f32 v73, v156, v157
v_mfma_f32_16x16x32_bf16 v[202:205], v[38:41], v[50:53], v[202:205]
ds_read_b128 v[50:53], v4 offset:13312
v_cvt_pk_bf16_f32 v132, v210, v211
v_mfma_f32_16x16x32_bf16 v[206:209], v[70:73], v[70:73], v[206:209]
v_cvt_pk_bf16_f32 v133, v212, v213
v_add_f32_e32 v223, v106, v107
v_mfma_f32_16x16x32_bf16 v[210:213], v[214:217], v[66:69], 0
v_add_f32_e32 v226, v108, v109
v_add_f32_e32 v226, v226, v223
v_mfma_f32_16x16x32_bf16 v[210:213], v[214:217], v[70:73], v[210:213]
v_rcp_f32_e32 v226, v226
v_mul_f32_dpp v106, v220, v106 quad_perm:[0,0,0,0] row_mask:0xf bank_mask:0xf
v_mul_f32_dpp v107, v220, v107 quad_perm:[1,1,1,1] row_mask:0xf bank_mask:0xf
v_mul_f32_dpp v108, v220, v108 quad_perm:[2,2,2,2] row_mask:0xf bank_mask:0xf
v_mul_f32_dpp v109, v220, v109 quad_perm:[3,3,3,3] row_mask:0xf bank_mask:0xf
v_cvt_pk_bf16_f32 v74, v158, v159
v_cvt_pk_bf16_f32 v75, v160, v161
v_cvt_pk_bf16_f32 v76, v162, v163
v_cvt_pk_bf16_f32 v77, v164, v165
v_mul_f32_e32 v106, v106, v226
v_mul_f32_e32 v107, v107, v226
v_mfma_f32_16x16x32_bf16 v[206:209], v[74:77], v[74:77], v[206:209]
v_mul_f32_e32 v108, v108, v226
v_mul_f32_e32 v109, v109, v226
v_mfma_f32_16x16x32_bf16 v[210:213], v[214:217], v[74:77], v[210:213]
v_cvt_pk_bf16_f32 v106, v106, v107
v_cvt_pk_bf16_f32 v107, v108, v109
v_cndmask_b32_e64 v106, 0, v106, s[40:41]
v_cndmask_b32_e64 v107, 0, v107, s[40:41]
v_lshlrev_b32_e32 v190, 16, v32
v_and_b32_e32 v191, 0xffff0000, v32
v_mfma_f32_16x16x16_bf16 v[166:169], v[126:127], v[106:107], v[166:169]
v_lshlrev_b32_e32 v192, 16, v33
v_and_b32_e32 v193, 0xffff0000, v33
v_cvt_pk_bf16_f32 v134, v194, v195
v_cvt_pk_bf16_f32 v135, v196, v197
v_mfma_f32_16x16x16_bf16 v[190:193], v[128:129], v[106:107], v[190:193]
v_lshlrev_b32_e32 v194, 16, v34
v_and_b32_e32 v195, 0xffff0000, v34
v_lshlrev_b32_e32 v196, 16, v35
v_and_b32_e32 v197, 0xffff0000, v35
v_lshlrev_b32_e32 v198, 16, v36
v_and_b32_e32 v199, 0xffff0000, v36
v_mfma_f32_16x16x16_bf16 v[194:197], v[130:131], v[106:107], v[194:197]
v_lshlrev_b32_e32 v200, 16, v37
v_and_b32_e32 v201, 0xffff0000, v37
v_cndmask_b32_e64 v222, v206, v207, s[42:43]
v_cndmask_b32_e64 v222, v222, v208, s[44:45]
v_mfma_f32_16x16x16_bf16 v[198:201], v[132:133], v[106:107], v[198:201]
v_cvt_pk_bf16_f32 v136, v202, v203
v_cvt_pk_bf16_f32 v137, v204, v205
v_cndmask_b32_e64 v222, v222, v209, s[46:47]
v_lshlrev_b32_e32 v202, 16, v38
v_and_b32_e32 v203, 0xffff0000, v38
v_lshlrev_b32_e32 v204, 16, v39
v_and_b32_e32 v205, 0xffff0000, v39
v_lshlrev_b32_e32 v206, 16, v40
v_and_b32_e32 v207, 0xffff0000, v40
v_mfma_f32_16x16x16_bf16 v[202:205], v[134:135], v[106:107], v[202:205]
v_lshlrev_b32_e32 v208, 16, v41
v_and_b32_e32 v209, 0xffff0000, v41
v_cvt_pk_bf16_f32 v78, v166, v167
v_cvt_pk_bf16_f32 v79, v168, v169
v_mfma_f32_16x16x16_bf16 v[206:209], v[136:137], v[106:107], v[206:209]
v_cvt_pk_bf16_f32 v80, v190, v191
v_cvt_pk_bf16_f32 v81, v192, v193
v_mul_f32_e32 v219, v210, v210
v_cvt_pk_bf16_f32 v82, v194, v195
v_mfma_f32_16x16x32_bf16 v[210:213], v[78:81], v[78:81], 0
v_cvt_pk_bf16_f32 v83, v196, v197
v_cvt_pk_bf16_f32 v84, v198, v199
v_mfma_f32_16x16x32_bf16 v[190:193], v[214:217], v[78:81], 0
v_cvt_pk_bf16_f32 v85, v200, v201
v_cvt_pk_bf16_f32 v86, v202, v203
s_waitcnt lgkmcnt(13)
v_mfma_f32_16x16x32_bf16 v[194:197], v[90:93], v[66:69], 0
v_cvt_pk_bf16_f32 v87, v204, v205
v_cvt_pk_bf16_f32 v88, v206, v207
v_mfma_f32_16x16x32_bf16 v[210:213], v[82:85], v[82:85], v[210:213]
v_cvt_pk_bf16_f32 v89, v208, v209
v_fma_f32 v222, v219, s55, v222
v_mfma_f32_16x16x32_bf16 v[190:193], v[214:217], v[82:85], v[190:193]
v_max_f32_e32 v222, 0, v222
v_add_f32_e32 v222, 0x3a7ba882, v222
v_mfma_f32_16x16x32_bf16 v[198:201], v[90:93], v[78:81], 0
ds_read_b128 v[90:93], v4 offset:14336
v_rsq_f32_e32 v219, v222
v_mfma_f32_16x16x32_bf16 v[210:213], v[86:89], v[86:89], v[210:213]
v_mul_f32_e32 v222, v222, v219
v_cvt_pk_bf16_f32 v222, v222, v222
v_mfma_f32_16x16x32_bf16 v[190:193], v[214:217], v[86:89], v[190:193]
v_mov_b32_e32 v158, v222
v_mov_b32_e32 v160, v219
s_waitcnt lgkmcnt(11)
v_mfma_f32_16x16x32_bf16 v[194:197], v[94:97], v[70:73], v[194:197]
v_mov_b32_e32 v161, v219
v_mov_b32_e32 v162, v222
v_mfma_f32_16x16x32_bf16 v[198:201], v[94:97], v[82:85], v[198:201]
ds_read_b128 v[94:97], v4 offset:15360
v_cndmask_b32_e64 v223, v210, v211, s[42:43]
s_waitcnt lgkmcnt(11)
v_mfma_f32_16x16x32_bf16 v[202:205], v[138:141], v[66:69], 0
v_cndmask_b32_e64 v223, v223, v212, s[44:45]
v_cndmask_b32_e64 v223, v223, v213, s[46:47]
v_mfma_f32_16x16x32_bf16 v[206:209], v[138:141], v[78:81], 0
ds_read_b128 v[138:141], v4 offset:17408
v_mul_f32_e32 v220, v190, v190
v_mfma_f32_16x16x32_bf16 v[194:197], v[98:101], v[74:77], v[194:197]
v_fma_f32 v223, v220, s55, v223
v_max_f32_e32 v223, 0, v223
v_mfma_f32_16x16x32_bf16 v[198:201], v[98:101], v[86:89], v[198:201]
ds_read_b128 v[98:101], v4 offset:16384
v_add_f32_e32 v223, 0x3a7ba882, v223
s_waitcnt lgkmcnt(11)
v_mfma_f32_16x16x32_bf16 v[202:205], v[142:145], v[70:73], v[202:205]
v_rsq_f32_e32 v220, v223
v_mfma_f32_16x16x32_bf16 v[206:209], v[142:145], v[82:85], v[206:209]
ds_read_b128 v[142:145], v4 offset:18432
v_cvt_pk_bf16_f32 v114, v194, v195
v_mfma_f32_16x16x32_bf16 v[210:213], v[170:173], v[66:69], 0
v_cvt_pk_bf16_f32 v115, v196, v197
v_cvt_pk_bf16_f32 v126, v198, v199
v_mfma_f32_16x16x32_bf16 v[190:193], v[170:173], v[78:81], 0
ds_read_b128 v[170:173], v4 offset:20480
v_cvt_pk_bf16_f32 v127, v200, v201
v_mfma_f32_16x16x32_bf16 v[202:205], v[146:149], v[74:77], v[202:205]
v_mul_f32_e32 v223, v223, v220
v_cvt_pk_bf16_f32 v223, v223, v223
v_mfma_f32_16x16x32_bf16 v[206:209], v[146:149], v[86:89], v[206:209]
ds_read_b128 v[146:149], v4 offset:19456
v_mov_b32_e32 v164, v219
s_waitcnt lgkmcnt(13)
v_mfma_f32_16x16x32_bf16 v[210:213], v[174:177], v[70:73], v[210:213]
v_mov_b32_e32 v165, 0
v_mov_b32_e32 v102, v223
v_mfma_f32_16x16x32_bf16 v[190:193], v[174:177], v[82:85], v[190:193]
ds_read_b128 v[174:177], v4 offset:21504
v_cvt_pk_bf16_f32 v116, v202, v203
s_waitcnt lgkmcnt(12)
v_mfma_f32_16x16x32_bf16 v[194:197], v[182:185], v[66:69], 0
v_cvt_pk_bf16_f32 v117, v204, v205
buffer_store_dwordx4 v[114:117], v249, s[12:15], s60 offen offset:192
v_mfma_f32_16x16x32_bf16 v[198:201], v[182:185], v[78:81], 0
ds_read_b128 v[182:185], v4 offset:23552
v_cvt_pk_bf16_f32 v128, v206, v207
v_mfma_f32_16x16x32_bf16 v[210:213], v[178:181], v[74:77], v[210:213]
v_cvt_pk_bf16_f32 v129, v208, v209
s_cmp_eq_u32 s37, 1
s_cbranch_scc1 L_xs406
buffer_store_dwordx4 v[126:129], v249, s[12:15], s61 offen offset:192
L_xs406:
v_mfma_f32_16x16x32_bf16 v[190:193], v[178:181], v[86:89], v[190:193]
ds_read_b128 v[178:181], v4 offset:22528
v_mov_b32_e32 v104, v220
s_waitcnt lgkmcnt(13)
v_mfma_f32_16x16x32_bf16 v[194:197], v[186:189], v[70:73], v[194:197]
v_mov_b32_e32 v105, v220
v_mov_b32_e32 v106, v223
v_mfma_f32_16x16x32_bf16 v[198:201], v[186:189], v[82:85], v[198:201]
ds_read_b128 v[186:189], v4 offset:24576
v_cvt_pk_bf16_f32 v118, v210, v211
s_waitcnt lgkmcnt(12)
v_mfma_f32_16x16x32_bf16 v[202:205], v[46:49], v[66:69], 0
v_cvt_pk_bf16_f32 v119, v212, v213
v_cvt_pk_bf16_f32 v130, v190, v191
v_mfma_f32_16x16x32_bf16 v[206:209], v[46:49], v[78:81], 0
ds_read_b128 v[46:49], v4 offset:26624
v_cvt_pk_bf16_f32 v131, v192, v193
v_mfma_f32_16x16x32_bf16 v[194:197], v[42:45], v[74:77], v[194:197]
v_mov_b32_e32 v108, v220
v_mov_b32_e32 v109, 0
v_mfma_f32_16x16x32_bf16 v[198:201], v[42:45], v[86:89], v[198:201]
ds_read_b128 v[42:45], v4 offset:25600
s_waitcnt lgkmcnt(13)
v_mfma_f32_16x16x32_bf16 v[202:205], v[50:53], v[70:73], v[202:205]
v_mfma_f32_16x16x32_bf16 v[206:209], v[50:53], v[82:85], v[206:209]
ds_read_b128 v[50:53], v4 offset:27648
s_waitcnt lgkmcnt(12)
v_mfma_f32_16x16x32_bf16 v[210:213], v[94:97], v[66:69], 0
v_cvt_pk_bf16_f32 v120, v194, v195
v_cvt_pk_bf16_f32 v121, v196, v197
buffer_store_dwordx4 v[118:121], v249, s[12:15], s60 offen offset:256
v_mfma_f32_16x16x32_bf16 v[190:193], v[94:97], v[78:81], 0
ds_read_b128 v[94:97], v4 offset:29696
v_cvt_pk_bf16_f32 v132, v198, v199
v_mfma_f32_16x16x32_bf16 v[202:205], v[90:93], v[74:77], v[202:205]
v_cvt_pk_bf16_f32 v133, v200, v201
s_cmp_eq_u32 s37, 1
s_cbranch_scc1 L_xs434
buffer_store_dwordx4 v[130:133], v249, s[12:15], s61 offen offset:256
L_xs434:
v_mfma_f32_16x16x32_bf16 v[206:209], v[90:93], v[86:89], v[206:209]
ds_read_b128 v[90:93], v4 offset:28672
s_waitcnt lgkmcnt(11)
v_mfma_f32_16x16x32_bf16 v[194:197], v[142:145], v[66:69], 0
v_mfma_f32_16x16x32_bf16 v[198:201], v[142:145], v[78:81], 0
ds_read_b128 v[142:145], v4 offset:32768
v_mfma_f32_16x16x32_bf16 v[210:213], v[98:101], v[70:73], v[210:213]
v_cvt_pk_bf16_f32 v122, v202, v203
v_cvt_pk_bf16_f32 v123, v204, v205
v_mfma_f32_16x16x32_bf16 v[190:193], v[98:101], v[82:85], v[190:193]
ds_read_b128 v[98:101], v4 offset:30720
v_cvt_pk_bf16_f32 v134, v206, v207
s_waitcnt lgkmcnt(11)
v_mfma_f32_16x16x32_bf16 v[194:197], v[146:149], v[70:73], v[194:197]
v_cvt_pk_bf16_f32 v135, v208, v209
v_mfma_f32_16x16x32_bf16 v[198:201], v[146:149], v[82:85], v[198:201]
ds_read_b128 v[146:149], v4 offset:33792
v_mfma_f32_16x16x32_bf16 v[210:213], v[138:141], v[74:77], v[210:213]
v_mfma_f32_16x16x32_bf16 v[190:193], v[138:141], v[86:89], v[190:193]
ds_read_b128 v[138:141], v4 offset:31744
s_waitcnt lgkmcnt(12)
v_mfma_f32_16x16x32_bf16 v[202:205], v[174:177], v[66:69], 0
v_mfma_f32_16x16x32_bf16 v[206:209], v[174:177], v[78:81], 0
ds_read_b128 v[174:177], v4 offset:35840
v_mfma_f32_16x16x32_bf16 v[194:197], v[170:173], v[74:77], v[194:197]
v_mfma_f32_16x16x32_bf16 v[198:201], v[170:173], v[86:89], v[198:201]
ds_read_b128 v[170:173], v4 offset:34816
v_cvt_pk_bf16_f32 v124, v210, v211
s_waitcnt lgkmcnt(12)
v_mfma_f32_16x16x32_bf16 v[202:205], v[178:181], v[70:73], v[202:205]
v_cvt_pk_bf16_f32 v125, v212, v213
buffer_store_dwordx4 v[122:125], v249, s[12:15], s60 offen offset:320
v_mfma_f32_16x16x32_bf16 v[206:209], v[178:181], v[82:85], v[206:209]
ds_read_b64_tr_b16 v[178:179], v250 offset:0
v_cvt_pk_bf16_f32 v150, v194, v195
v_mfma_f32_16x16x32_bf16 v[202:205], v[182:185], v[74:77], v[202:205]
ds_read_b64_tr_b16 v[180:181], v250 offset:3072
v_cvt_pk_bf16_f32 v151, v196, v197
v_mfma_f32_16x16x32_bf16 v[206:209], v[182:185], v[86:89], v[206:209]
ds_read_b64_tr_b16 v[182:183], v250 offset:6144
v_cvt_pk_bf16_f32 v154, v198, v199
s_waitcnt lgkmcnt(14)
v_mfma_f32_16x16x32_bf16 v[210:213], v[186:189], v[66:69], 0
ds_read_b64_tr_b16 v[184:185], v250 offset:9216
v_cvt_pk_bf16_f32 v155, v200, v201
v_cvt_pk_bf16_f32 v136, v190, v191
s_waitcnt lgkmcnt(13)
v_mfma_f32_16x16x32_bf16 v[210:213], v[42:45], v[70:73], v[210:213]
v_cvt_pk_bf16_f32 v137, v192, v193
s_cmp_eq_u32 s37, 1
s_cbranch_scc1 L_xs462
buffer_store_dwordx4 v[134:137], v249, s[12:15], s61 offen offset:320
L_xs462:
v_mfma_f32_16x16x32_bf16 v[190:193], v[186:189], v[78:81], 0
ds_read_b64_tr_b16 v[186:187], v250 offset:12288
v_perm_b32 v194, v66, v150, s62
v_mfma_f32_16x16x32_bf16 v[210:213], v[46:49], v[74:77], v[210:213]
ds_read_b64_tr_b16 v[188:189], v250 offset:15360
v_perm_b32 v195, v66, v150, s63
v_mfma_f32_16x16x32_bf16 v[190:193], v[42:45], v[82:85], v[190:193]
ds_read_b64_tr_b16 v[42:43], v250 offset:8
v_perm_b32 v196, v67, v151, s62
v_perm_b32 v197, v67, v151, s63
buffer_store_dwordx4 v[194:197], v249, s[12:15], s60 offen offset:384
ds_read_b64_tr_b16 v[44:45], v250 offset:3080
v_mfma_f32_16x16x32_bf16 v[190:193], v[46:49], v[86:89], v[190:193]
ds_read_b64_tr_b16 v[46:47], v250 offset:6152
v_perm_b32 v198, v78, v154, s62
s_waitcnt lgkmcnt(15)
v_mfma_f32_16x16x32_bf16 v[194:197], v[50:53], v[66:69], 0
ds_read_b64_tr_b16 v[48:49], v250 offset:9224
v_perm_b32 v199, v78, v154, s63
v_perm_b32 v200, v79, v155, s62
s_waitcnt lgkmcnt(15)
v_mfma_f32_16x16x32_bf16 v[194:197], v[90:93], v[70:73], v[194:197]
v_perm_b32 v201, v79, v155, s63
s_cmp_eq_u32 s37, 1
s_cbranch_scc1 L_xs485
buffer_store_dwordx4 v[198:201], v249, s[12:15], s61 offen offset:384
L_xs485:
v_mfma_f32_16x16x32_bf16 v[194:197], v[94:97], v[74:77], v[194:197]
v_cvt_pk_bf16_f32 v152, v202, v203
v_cvt_pk_bf16_f32 v153, v204, v205
v_mfma_f32_16x16x32_bf16 v[198:201], v[50:53], v[78:81], 0
ds_read_b64_tr_b16 v[50:51], v250 offset:12296
v_cvt_pk_bf16_f32 v156, v206, v207
v_cvt_pk_bf16_f32 v157, v208, v209
ds_read_b64_tr_b16 v[52:53], v250 offset:15368
v_mfma_f32_16x16x32_bf16 v[198:201], v[90:93], v[82:85], v[198:201]
ds_read_b64_tr_b16 v[90:91], v250 offset:1024
v_perm_b32 v202, v68, v152, s62
v_perm_b32 v203, v68, v152, s63
ds_read_b64_tr_b16 v[92:93], v250 offset:4096
v_mfma_f32_16x16x32_bf16 v[198:201], v[94:97], v[86:89], v[198:201]
ds_read_b64_tr_b16 v[94:95], v250 offset:7168
v_perm_b32 v204, v69, v153, s62
v_perm_b32 v205, v69, v153, s63
buffer_store_dwordx4 v[202:205], v249, s[12:15], s60 offen offset:448
ds_read_b64_tr_b16 v[96:97], v250 offset:10240
v_perm_b32 v206, v80, v156, s62
s_waitcnt lgkmcnt(15)
v_mfma_f32_16x16x32_bf16 v[202:205], v[98:101], v[66:69], 0
v_perm_b32 v207, v80, v156, s63
v_perm_b32 v208, v81, v157, s62
s_waitcnt lgkmcnt(15)
v_mfma_f32_16x16x32_bf16 v[202:205], v[138:141], v[70:73], v[202:205]
v_perm_b32 v209, v81, v157, s63
s_cmp_eq_u32 s37, 1
s_cbranch_scc1 L_xs508
buffer_store_dwordx4 v[206:209], v249, s[12:15], s61 offen offset:448
L_xs508:
v_mfma_f32_16x16x32_bf16 v[202:205], v[142:145], v[74:77], v[202:205]
v_cvt_pk_bf16_f32 v150, v210, v211
v_cvt_pk_bf16_f32 v151, v212, v213
v_mfma_f32_16x16x32_bf16 v[206:209], v[98:101], v[78:81], 0
ds_read_b64_tr_b16 v[98:99], v250 offset:13312
v_cvt_pk_bf16_f32 v154, v190, v191
v_cvt_pk_bf16_f32 v155, v192, v193
ds_read_b64_tr_b16 v[100:101], v250 offset:16384
v_mfma_f32_16x16x32_bf16 v[206:209], v[138:141], v[82:85], v[206:209]
ds_read_b64_tr_b16 v[138:139], v250 offset:1032
v_cvt_pk_bf16_f32 v152, v194, v195
v_cvt_pk_bf16_f32 v153, v196, v197
ds_read_b64_tr_b16 v[140:141], v250 offset:4104
v_mfma_f32_16x16x32_bf16 v[206:209], v[142:145], v[86:89], v[206:209]
ds_read_b64_tr_b16 v[142:143], v250 offset:7176
v_perm_b32 v210, v70, v150, s62
v_perm_b32 v211, v70, v150, s63
ds_read_b64_tr_b16 v[144:145], v250 offset:10248
v_perm_b32 v212, v71, v151, s62
v_perm_b32 v213, v71, v151, s63
buffer_store_dwordx4 v[210:213], v249, s[12:15], s60 offen offset:512
v_cvt_pk_bf16_f32 v156, v198, v199
v_cvt_pk_bf16_f32 v157, v200, v201
v_mfma_f32_16x16x32_bf16 v[210:213], v[146:149], v[66:69], 0
v_perm_b32 v190, v82, v154, s62
v_perm_b32 v191, v82, v154, s63
s_waitcnt lgkmcnt(15)
v_mfma_f32_16x16x32_bf16 v[210:213], v[170:173], v[70:73], v[210:213]
v_perm_b32 v192, v83, v155, s62
v_perm_b32 v193, v83, v155, s63
s_cmp_eq_u32 s37, 1
s_cbranch_scc1 L_xs531
buffer_store_dwordx4 v[190:193], v249, s[12:15], s61 offen offset:512
L_xs531:
v_mfma_f32_16x16x32_bf16 v[210:213], v[174:177], v[74:77], v[210:213]
v_perm_b32 v194, v72, v152, s62
v_perm_b32 v195, v72, v152, s63
v_mfma_f32_16x16x32_bf16 v[190:193], v[146:149], v[78:81], 0
ds_read_b64_tr_b16 v[146:147], v250 offset:13320
v_perm_b32 v196, v73, v153, s62
v_perm_b32 v197, v73, v153, s63
buffer_store_dwordx4 v[194:197], v249, s[12:15], s60 offen offset:576
ds_read_b64_tr_b16 v[148:149], v250 offset:16392
v_mfma_f32_16x16x32_bf16 v[190:193], v[170:173], v[82:85], v[190:193]
ds_read_b64_tr_b16 v[170:171], v250 offset:2048
v_perm_b32 v198, v84, v156, s62
s_waitcnt lgkmcnt(15)
v_mfma_f32_16x16x32_bf16 v[194:197], v[178:181], v[66:69], 0
ds_read_b64_tr_b16 v[172:173], v250 offset:5120
v_perm_b32 v199, v84, v156, s63
v_mfma_f32_16x16x32_bf16 v[190:193], v[174:177], v[86:89], v[190:193]
ds_read_b64_tr_b16 v[174:175], v250 offset:8192
v_perm_b32 v200, v85, v157, s62
s_waitcnt lgkmcnt(15)
v_mfma_f32_16x16x32_bf16 v[194:197], v[182:185], v[70:73], v[194:197]
ds_read_b64_tr_b16 v[176:177], v250 offset:11264
v_perm_b32 v201, v85, v157, s63
s_cmp_eq_u32 s37, 1
s_cbranch_scc1 L_xs554
buffer_store_dwordx4 v[198:201], v249, s[12:15], s61 offen offset:576
L_xs554:
s_waitcnt lgkmcnt(15)
v_mfma_f32_16x16x32_bf16 v[194:197], v[186:189], v[74:77], v[194:197]
v_cvt_pk_bf16_f32 v150, v202, v203
v_cvt_pk_bf16_f32 v151, v204, v205
v_mfma_f32_16x16x32_bf16 v[198:201], v[178:181], v[78:81], 0
ds_read_b64_tr_b16 v[178:179], v250 offset:14336
v_cvt_pk_bf16_f32 v154, v206, v207
v_cvt_pk_bf16_f32 v155, v208, v209
ds_read_b64_tr_b16 v[180:181], v250 offset:17408
v_mfma_f32_16x16x32_bf16 v[198:201], v[182:185], v[82:85], v[198:201]
ds_read_b64_tr_b16 v[182:183], v250 offset:2056
v_cvt_pk_bf16_f32 v18, v194, v195
v_cvt_pk_bf16_f32 v19, v196, v197
ds_read_b64_tr_b16 v[184:185], v250 offset:5128
v_mfma_f32_16x16x32_bf16 v[198:201], v[186:189], v[86:89], v[198:201]
ds_read_b64_tr_b16 v[186:187], v250 offset:8200
v_cvt_pk_bf16_f32 v152, v210, v211
s_waitcnt lgkmcnt(13)
v_mfma_f32_16x16x32_bf16 v[194:197], v[138:141], v[66:69], 0
ds_read_b64_tr_b16 v[188:189], v250 offset:11272
v_cvt_pk_bf16_f32 v153, v212, v213
v_cvt_pk_bf16_f32 v156, v190, v191
s_waitcnt lgkmcnt(12)
v_mfma_f32_16x16x32_bf16 v[194:197], v[142:145], v[70:73], v[194:197]
v_cvt_pk_bf16_f32 v157, v192, v193
v_cvt_pk_bf16_f32 v30, v198, v199
s_waitcnt lgkmcnt(10)
v_mfma_f32_16x16x32_bf16 v[194:197], v[146:149], v[74:77], v[194:197]
v_cvt_pk_bf16_f32 v31, v200, v201
v_perm_b32 v202, v74, v150, s62
v_mfma_f32_16x16x32_bf16 v[198:201], v[138:141], v[78:81], 0
v_perm_b32 v203, v74, v150, s63
v_perm_b32 v204, v75, v151, s62
v_mfma_f32_16x16x32_bf16 v[198:201], v[142:145], v[82:85], v[198:201]
v_perm_b32 v205, v75, v151, s63
buffer_store_dwordx4 v[202:205], v249, s[12:15], s60 offen offset:640
v_mfma_f32_16x16x32_bf16 v[198:201], v[146:149], v[86:89], v[198:201]
v_perm_b32 v206, v86, v154, s62
v_perm_b32 v207, v86, v154, s63
v_mfma_f32_16x16x32_bf16 v[202:205], v[42:45], v[66:69], 0
v_perm_b32 v208, v87, v155, s62
v_perm_b32 v209, v87, v155, s63
s_cmp_eq_u32 s37, 1
s_cbranch_scc1 L_xs577
buffer_store_dwordx4 v[206:209], v249, s[12:15], s61 offen offset:640
L_xs577:
v_mfma_f32_16x16x32_bf16 v[202:205], v[46:49], v[70:73], v[202:205]
v_perm_b32 v210, v76, v152, s62
v_perm_b32 v211, v76, v152, s63
v_mfma_f32_16x16x32_bf16 v[206:209], v[42:45], v[78:81], 0
ds_read_b64_tr_b16 v[42:43], v250 offset:14344
v_perm_b32 v212, v77, v153, s62
v_mfma_f32_16x16x32_bf16 v[202:205], v[50:53], v[74:77], v[202:205]
ds_read_b64_tr_b16 v[44:45], v250 offset:17416
v_perm_b32 v213, v77, v153, s63
buffer_store_dwordx4 v[210:213], v249, s[12:15], s60 offen offset:704
v_mfma_f32_16x16x32_bf16 v[206:209], v[46:49], v[82:85], v[206:209]
v_perm_b32 v190, v88, v156, s62
v_perm_b32 v191, v88, v156, s63
v_mfma_f32_16x16x32_bf16 v[210:213], v[90:93], v[66:69], 0
v_perm_b32 v192, v89, v157, s62
v_perm_b32 v193, v89, v157, s63
s_cmp_eq_u32 s37, 1
s_cbranch_scc1 L_xs600
buffer_store_dwordx4 v[190:193], v249, s[12:15], s61 offen offset:704
L_xs600:
v_mfma_f32_16x16x32_bf16 v[210:213], v[94:97], v[70:73], v[210:213]
v_cvt_pk_bf16_f32 v24, v194, v195
v_cvt_pk_bf16_f32 v25, v196, v197
v_mfma_f32_16x16x32_bf16 v[190:193], v[90:93], v[78:81], 0
v_cvt_pk_bf16_f32 v36, v198, v199
v_cvt_pk_bf16_f32 v37, v200, v201
v_mfma_f32_16x16x32_bf16 v[190:193], v[94:97], v[82:85], v[190:193]
v_cvt_pk_bf16_f32 v20, v202, v203
v_cvt_pk_bf16_f32 v21, v204, v205
buffer_store_dwordx4 v[18:21], v249, s[12:15], s60 offen offset:0
v_mfma_f32_16x16x32_bf16 v[210:213], v[98:101], v[74:77], v[210:213]
v_mfma_f32_16x16x32_bf16 v[206:209], v[50:53], v[86:89], v[206:209]
v_mfma_f32_16x16x32_bf16 v[190:193], v[98:101], v[86:89], v[190:193]
v_mfma_f32_16x16x32_bf16 v[194:197], v[66:69], v[114:117], 0
v_mfma_f32_16x16x32_bf16 v[198:201], v[78:81], v[126:129], 0
s_waitcnt lgkmcnt(10)
v_mfma_f32_16x16x32_bf16 v[202:205], v[170:173], v[66:69], 0
v_mfma_f32_16x16x32_bf16 v[194:197], v[70:73], v[118:121], v[194:197]
v_mfma_f32_16x16x32_bf16 v[198:201], v[82:85], v[130:133], v[198:201]
s_waitcnt lgkmcnt(8)
v_mfma_f32_16x16x32_bf16 v[202:205], v[174:177], v[70:73], v[202:205]
v_cvt_pk_bf16_f32 v22, v210, v211
v_cvt_pk_bf16_f32 v23, v212, v213
s_waitcnt lgkmcnt(4)
v_mfma_f32_16x16x32_bf16 v[210:213], v[182:185], v[66:69], 0
v_cvt_pk_bf16_f32 v32, v206, v207
v_cvt_pk_bf16_f32 v33, v208, v209
s_cmp_eq_u32 s37, 1
s_cbranch_scc1 L_xs634
buffer_store_dwordx4 v[30:33], v249, s[12:15], s61 offen offset:0
L_xs634:
buffer_store_dwordx4 v[22:25], v249, s[12:15], s60 offen offset:64
v_mfma_f32_16x16x32_bf16 v[206:209], v[170:173], v[78:81], 0
v_cvt_pk_bf16_f32 v34, v190, v191
v_cvt_pk_bf16_f32 v35, v192, v193
s_cmp_eq_u32 s37, 1
s_cbranch_scc1 L_xs668
buffer_store_dwordx4 v[34:37], v249, s[12:15], s61 offen offset:64
L_xs668:
v_mfma_f32_16x16x32_bf16 v[190:193], v[182:185], v[78:81], 0
s_waitcnt lgkmcnt(2)
v_mfma_f32_16x16x32_bf16 v[210:213], v[186:189], v[70:73], v[210:213]
v_mfma_f32_16x16x32_bf16 v[206:209], v[174:177], v[82:85], v[206:209]
v_mfma_f32_16x16x32_bf16 v[190:193], v[186:189], v[82:85], v[190:193]
v_mfma_f32_16x16x32_bf16 v[194:197], v[74:77], v[122:125], v[194:197]
v_mfma_f32_16x16x32_bf16 v[198:201], v[86:89], v[134:137], v[198:201]
v_mfma_f32_16x16x32_bf16 v[202:205], v[178:181], v[74:77], v[202:205]
s_waitcnt lgkmcnt(0)
v_mfma_f32_16x16x32_bf16 v[210:213], v[42:45], v[74:77], v[210:213]
v_mfma_f32_16x16x32_bf16 v[206:209], v[178:181], v[86:89], v[206:209]
v_mfma_f32_16x16x32_bf16 v[190:193], v[42:45], v[86:89], v[190:193]
s_nop 1
v_cndmask_b32_e64 v194, v194, v195, s[42:43]
v_cndmask_b32_e64 v194, v194, v196, s[44:45]
v_cndmask_b32_e64 v194, v194, v197, s[46:47]
v_mul_f32_e32 v194, v194, v219
v_cndmask_b32_e64 v198, v198, v199, s[42:43]
v_cndmask_b32_e64 v198, v198, v200, s[44:45]
v_cndmask_b32_e64 v198, v198, v201, s[46:47]
v_cvt_pk_bf16_f32 v26, v202, v203
v_cvt_pk_bf16_f32 v27, v204, v205
v_cvt_pk_bf16_f32 v28, v210, v211
v_cvt_pk_bf16_f32 v29, v212, v213
buffer_store_dwordx4 v[26:29], v249, s[12:15], s60 offen offset:128
v_mul_f32_e32 v198, v198, v220
v_cvt_pk_bf16_f32 v38, v206, v207
v_cvt_pk_bf16_f32 v39, v208, v209
v_cvt_pk_bf16_f32 v40, v190, v191
v_cvt_pk_bf16_f32 v41, v192, v193
s_cmp_eq_u32 s37, 1
s_cbranch_scc1 L_xs702
buffer_store_dwordx4 v[38:41], v249, s[12:15], s61 offen offset:128
L_xs702:
v_and_b32_e32 v159, 0xffffff7f, v194
buffer_store_dwordx4 v[158:161], v251, s[12:15], s60 offen offset:768
v_and_b32_e32 v163, 0xffffff7f, v194
buffer_store_dwordx4 v[162:165], v251, s[12:15], s60 offen offset:784
v_and_b32_e32 v103, 0xffffff7f, v198
s_cmp_eq_u32 s37, 1
s_cbranch_scc1 L_xs731
buffer_store_dwordx4 v[102:105], v251, s[12:15], s61 offen offset:768
L_xs731:
v_and_b32_e32 v107, 0xffffff7f, v198
s_cmp_eq_u32 s37, 1
s_cbranch_scc1 L_xs736
buffer_store_dwordx4 v[106:109], v251, s[12:15], s61 offen offset:784
L_xs736:
s_setprio 0
L_noex:
s_nop 8
v_mbcnt_lo_u32_b32 v20, -1, 0
v_mbcnt_hi_u32_b32 v20, -1, v20
v_lshrrev_b32 v22, 4, v20
v_bfe_u32 v23, v20, 2, 2
v_and_b32 v24, 3, v20
v_sub_u32 v25, v23, v24
v_mul_i32_i24 v25, 9280, v25
v_sub_u32 v26, v22, v23
v_lshl_add_u32 v25, v26, 4, v25
v_sub_u32 v26, v24, v22
v_lshl_add_u32 v25, v26, 8, v25
v_add_u32 v250, v25, v5
v_add_u32 v254, v25, v6
v_add_u32 v255, v25, v7
v_subrev_u32 v25, 1, v23
v_and_b32 v25, 3, v25
v_sub_u32 v25, v25, v23
v_lshl_add_u32 v64, v25, 4, v6
v_add_u32 v25, 1, v23
v_and_b32 v25, 3, v25
v_cmp_eq_u32 s[86:87], v25, v22
v_subrev_u32 v25, 2, v23
v_and_b32 v25, 3, v25
v_sub_u32 v25, v25, v23
v_lshl_add_u32 v65, v25, 4, v7
v_add_u32 v25, 2, v23
v_and_b32 v25, 3, v25
v_cmp_eq_u32 s[88:89], v25, v22
s_waitcnt vmcnt(0) lgkmcnt(0)

s_barrier

s_mov_b32 s48, 0
s_lshl_b32 s52, s2, 17
s_lshl_b32 s59, s58, 16
s_add_u32 s52, s52, s59
s_lshl_b32 s59, s57, 10
s_add_u32 s52, s52, s59
v_subrev_u32_e32 v186, 36864, v4
ds_read_b128 v[170:173], v186 offset:0
ds_read_b128 v[174:177], v186 offset:1024
ds_read_b128 v[178:181], v186 offset:2048
ds_read_b128 v[182:185], v186 offset:3072
ds_read_b128 v[186:189], v186 offset:4096
L_loop:
s_mov_b32 s90, s50
s_mov_b32 s50, s51
s_add_u32 s59, s48, 1
s_lshl_b32 s60, s59, 9
s_add_u32 s60, s60, s56
s_add_u32 s61, s2, 5120
s_cmp_lt_u32 s59, 10
s_cselect_b32 s60, s60, s61
s_mul_i32 s61, s60, 7183
s_lshr_b32 s61, s61, 19
s_mul_i32 s62, s61, 73
s_sub_u32 s60, s60, s62
s_mul_i32 s60, s60, 1344
s_mul_i32 s61, s61, 686784
s_add_u32 s60, s60, s61
s_cmp_lt_u32 s59, s49
s_cselect_b32 s51, s60, 0x40000000
s_cmp_eq_u32 s48, 0
s_cbranch_scc1 L_ns20
buffer_store_dwordx4 v[42:45], v2, s[8:11], s90 offen offset:0
L_ns20:
ds_read_b128 v[122:125], v5 offset:0
v_mov_b32_e32 v214, 0x3f803f80
v_mov_b32_e32 v215, 0x3f803f80
v_mov_b32_e32 v216, 0x3f803f80
v_mov_b32_e32 v217, 0x3f803f80
ds_read_b128 v[134:137], v6 offset:0
v_subrev_u32_e32 v218, 36864, v4
ds_read_b128 v[158:161], v64 offset:0
ds_read_b128 v[126:129], v5 offset:1024
ds_read_b128 v[138:141], v6 offset:1024
ds_read_b128 v[162:165], v64 offset:1024
s_waitcnt lgkmcnt(5)
v_mfma_f32_16x16x32_bf16 v[190:193], v[122:125], v[122:125], 0
ds_read_b128 v[130:133], v5 offset:2048
v_mfma_f32_16x16x32_bf16 v[194:197], v[214:217], v[122:125], 0
ds_read_b128 v[142:145], v6 offset:2048
s_waitcnt lgkmcnt(6)
v_mfma_f32_16x16x32_bf16 v[202:205], v[214:217], v[134:137], 0
ds_read_b128 v[166:169], v64 offset:2048
s_waitcnt lgkmcnt(6)
v_mfma_f32_16x16x32_bf16 v[198:201], v[158:161], v[134:137], 0
ds_read_b128 v[146:149], v7 offset:0
s_waitcnt lgkmcnt(6)
v_mfma_f32_16x16x32_bf16 v[190:193], v[126:129], v[126:129], v[190:193]
ds_read_b128 v[110:113], v65 offset:0
v_mfma_f32_16x16x32_bf16 v[194:197], v[214:217], v[126:129], v[194:197]
ds_read_b128 v[150:153], v7 offset:1024
s_waitcnt lgkmcnt(6)
v_mfma_f32_16x16x32_bf16 v[198:201], v[162:165], v[138:141], v[198:201]
ds_read_b128 v[114:117], v65 offset:1024
s_waitcnt lgkmcnt(6)
v_mfma_f32_16x16x32_bf16 v[190:193], v[130:133], v[130:133], v[190:193]
ds_read_b128 v[154:157], v7 offset:2048
v_mfma_f32_16x16x32_bf16 v[194:197], v[214:217], v[130:133], v[194:197]
ds_read_b128 v[118:121], v65 offset:2048
s_waitcnt lgkmcnt(6)
v_mfma_f32_16x16x32_bf16 v[198:201], v[166:169], v[142:145], v[198:201]
ds_read_b64_tr_b16 v[60:61], v250 offset:0
s_waitcnt lgkmcnt(6)
v_mfma_f32_16x16x32_bf16 v[210:213], v[214:217], v[146:149], 0
ds_read_b64_tr_b16 v[228:229], v254 offset:0
s_waitcnt lgkmcnt(6)
v_mfma_f32_16x16x32_bf16 v[206:209], v[110:113], v[146:149], 0
ds_read_b64_tr_b16 v[232:233], v255 offset:0
v_cndmask_b32_e64 v222, v190, v191, s[42:43]
v_mfma_f32_16x16x32_bf16 v[202:205], v[214:217], v[138:141], v[202:205]
v_cndmask_b32_e64 v222, v222, v192, s[44:45]
v_cndmask_b32_e64 v223, v198, v199, s[42:43]
s_waitcnt lgkmcnt(5)
v_mfma_f32_16x16x32_bf16 v[206:209], v[114:117], v[150:153], v[206:209]
v_cndmask_b32_e64 v223, v223, v200, s[44:45]
v_cndmask_b32_e64 v222, v222, v193, s[46:47]
s_cmp_eq_u32 s48, 0
s_cbranch_scc1 L_ns21
buffer_store_dwordx4 v[46:49], v2, s[8:11], s90 offen offset:64
L_ns21:
v_mfma_f32_16x16x32_bf16 v[190:193], v[170:173], v[122:125], 0
v_mov_b32_e32 v225, v194
v_cndmask_b32_e64 v223, v223, v201, s[46:47]
v_mfma_f32_16x16x32_bf16 v[194:197], v[170:173], v[134:137], 0
v_cndmask_b32_e64 v222, v222, v223, s[86:87]
v_mfma_f32_16x16x32_bf16 v[198:201], v[170:173], v[146:149], 0
ds_read_b128 v[170:173], v218 offset:5120
v_mfma_f32_16x16x32_bf16 v[210:213], v[214:217], v[150:153], v[210:213]
v_mfma_f32_16x16x32_bf16 v[190:193], v[174:177], v[126:129], v[190:193]
v_mfma_f32_16x16x32_bf16 v[194:197], v[174:177], v[138:141], v[194:197]
v_mfma_f32_16x16x32_bf16 v[198:201], v[174:177], v[150:153], v[198:201]
ds_read_b128 v[174:177], v218 offset:6144
s_waitcnt lgkmcnt(5)
v_mfma_f32_16x16x32_bf16 v[206:209], v[118:121], v[154:157], v[206:209]
v_mfma_f32_16x16x32_bf16 v[202:205], v[214:217], v[142:145], v[202:205]
v_mfma_f32_16x16x32_bf16 v[210:213], v[214:217], v[154:157], v[210:213]
v_mfma_f32_16x16x32_bf16 v[190:193], v[178:181], v[130:133], v[190:193]
v_mfma_f32_16x16x32_bf16 v[194:197], v[178:181], v[142:145], v[194:197]
v_mfma_f32_16x16x32_bf16 v[198:201], v[178:181], v[154:157], v[198:201]
ds_read_b128 v[178:181], v218 offset:7168
s_nop 1
v_cndmask_b32_e64 v224, v206, v207, s[42:43]
v_cndmask_b32_e64 v224, v224, v208, s[44:45]
v_cndmask_b32_e64 v224, v224, v209, s[46:47]
v_mfma_f32_16x16x32_bf16 v[206:209], v[182:185], v[134:137], 0
v_cndmask_b32_e64 v225, v225, v202, s[86:87]
v_cndmask_b32_e64 v225, v225, v210, s[88:89]
v_mfma_f32_16x16x32_bf16 v[202:205], v[182:185], v[122:125], 0
v_cvt_pk_bf16_f32 v66, v190, v191
v_cvt_pk_bf16_f32 v67, v192, v193
v_mfma_f32_16x16x32_bf16 v[210:213], v[182:185], v[146:149], 0
ds_read_b128 v[182:185], v218 offset:8192
v_cvt_pk_bf16_f32 v78, v194, v195
v_mfma_f32_16x16x32_bf16 v[202:205], v[186:189], v[126:129], v[202:205]
v_cvt_pk_bf16_f32 v79, v196, v197
v_cvt_pk_bf16_f32 v90, v198, v199
v_mfma_f32_16x16x32_bf16 v[206:209], v[186:189], v[138:141], v[206:209]
v_cvt_pk_bf16_f32 v91, v200, v201
v_cndmask_b32_e64 v222, v222, v224, s[88:89]
v_mfma_f32_16x16x32_bf16 v[210:213], v[186:189], v[150:153], v[210:213]
ds_read_b128 v[186:189], v218 offset:9216
v_mul_f32_e32 v225, v225, v225
s_cmp_eq_u32 s48, 0
s_cbranch_scc1 L_ns22
buffer_store_dwordx4 v[50:53], v2, s[8:11], s90 offen offset:128
L_ns22:
s_waitcnt lgkmcnt(4)
v_mfma_f32_16x16x32_bf16 v[202:205], v[170:173], v[130:133], v[202:205]
v_fma_f32 v222, v225, s55, v222
v_max_f32_e32 v222, 0, v222
v_mfma_f32_16x16x32_bf16 v[206:209], v[170:173], v[142:145], v[206:209]
v_add_f32_e32 v222, 0x3a7ba882, v222
v_rsq_f32_e32 v247, v222
v_mfma_f32_16x16x32_bf16 v[210:213], v[170:173], v[154:157], v[210:213]
ds_read_b128 v[170:173], v218 offset:10240
s_waitcnt lgkmcnt(4)
v_mfma_f32_16x16x32_bf16 v[190:193], v[174:177], v[122:125], 0
v_cvt_pk_bf16_f32 v68, v202, v203
v_cvt_pk_bf16_f32 v69, v204, v205
v_mfma_f32_16x16x32_bf16 v[194:197], v[174:177], v[134:137], 0
v_cvt_pk_bf16_f32 v80, v206, v207
v_cvt_pk_bf16_f32 v81, v208, v209
v_mfma_f32_16x16x32_bf16 v[198:201], v[174:177], v[146:149], 0
ds_read_b128 v[174:177], v218 offset:11264
v_cvt_pk_bf16_f32 v92, v210, v211
s_waitcnt lgkmcnt(4)
v_mfma_f32_16x16x32_bf16 v[190:193], v[178:181], v[126:129], v[190:193]
v_cvt_pk_bf16_f32 v93, v212, v213
v_mfma_f32_16x16x32_bf16 v[194:197], v[178:181], v[138:141], v[194:197]
v_mfma_f32_16x16x32_bf16 v[198:201], v[178:181], v[150:153], v[198:201]
ds_read_b128 v[178:181], v218 offset:12288
s_waitcnt lgkmcnt(3)
v_mfma_f32_16x16x32_bf16 v[202:205], v[186:189], v[122:125], 0
v_mfma_f32_16x16x32_bf16 v[206:209], v[186:189], v[134:137], 0
v_mfma_f32_16x16x32_bf16 v[210:213], v[186:189], v[146:149], 0
ds_read_b128 v[186:189], v218 offset:14336
s_waitcnt lgkmcnt(3)
v_mfma_f32_16x16x32_bf16 v[202:205], v[170:173], v[126:129], v[202:205]
v_mfma_f32_16x16x32_bf16 v[206:209], v[170:173], v[138:141], v[206:209]
v_mfma_f32_16x16x32_bf16 v[210:213], v[170:173], v[150:153], v[210:213]
ds_read_b128 v[170:173], v218 offset:15360
v_mfma_f32_16x16x32_bf16 v[190:193], v[182:185], v[130:133], v[190:193]
v_mfma_f32_16x16x32_bf16 v[194:197], v[182:185], v[142:145], v[194:197]
v_mfma_f32_16x16x32_bf16 v[198:201], v[182:185], v[154:157], v[198:201]
ds_read_b128 v[182:185], v218 offset:13312
s_waitcnt lgkmcnt(4)
v_mfma_f32_16x16x32_bf16 v[202:205], v[174:177], v[130:133], v[202:205]
v_mfma_f32_16x16x32_bf16 v[206:209], v[174:177], v[142:145], v[206:209]
v_mfma_f32_16x16x32_bf16 v[210:213], v[174:177], v[154:157], v[210:213]
ds_read_b128 v[174:177], v218 offset:16384
v_mfma_f32_16x16x32_bf16 v[102:105], v[122:125], v[66:69], 0
v_cvt_pk_bf16_f32 v70, v190, v191
v_cvt_pk_bf16_f32 v71, v192, v193
s_waitcnt lgkmcnt(4)
v_mfma_f32_16x16x32_bf16 v[190:193], v[178:181], v[122:125], 0
v_cvt_pk_bf16_f32 v82, v194, v195
v_cvt_pk_bf16_f32 v83, v196, v197
v_mfma_f32_16x16x32_bf16 v[194:197], v[178:181], v[134:137], 0
v_cvt_pk_bf16_f32 v94, v198, v199
v_cvt_pk_bf16_f32 v95, v200, v201
v_mfma_f32_16x16x32_bf16 v[198:201], v[178:181], v[146:149], 0
ds_read_b128 v[178:181], v218 offset:17408
v_cvt_pk_bf16_f32 v72, v202, v203
s_waitcnt lgkmcnt(2)
v_mfma_f32_16x16x32_bf16 v[190:193], v[182:185], v[126:129], v[190:193]
v_cvt_pk_bf16_f32 v73, v204, v205
v_cvt_pk_bf16_f32 v84, v206, v207
v_mfma_f32_16x16x32_bf16 v[202:205], v[170:173], v[122:125], 0
v_cvt_pk_bf16_f32 v85, v208, v209
v_cvt_pk_bf16_f32 v96, v210, v211
v_mfma_f32_16x16x32_bf16 v[206:209], v[170:173], v[134:137], 0
ds_read_b64_tr_b16 v[136:137], v250 offset:8
v_cvt_pk_bf16_f32 v97, v212, v213
v_mfma_f32_16x16x32_bf16 v[210:213], v[170:173], v[146:149], 0
ds_read_b128 v[170:173], v218 offset:20480
v_mfma_f32_16x16x32_bf16 v[194:197], v[182:185], v[138:141], v[194:197]
ds_read_b64_tr_b16 v[148:149], v250 offset:1024
s_waitcnt lgkmcnt(4)
v_mfma_f32_16x16x32_bf16 v[202:205], v[174:177], v[126:129], v[202:205]
s_setprio 2
v_mfma_f32_16x16x32_bf16 v[206:209], v[174:177], v[138:141], v[206:209]
ds_read_b64_tr_b16 v[140:141], v254 offset:8
v_mfma_f32_16x16x32_bf16 v[198:201], v[182:185], v[150:153], v[198:201]
ds_read_b128 v[182:185], v218 offset:18432
v_mfma_f32_16x16x32_bf16 v[210:213], v[174:177], v[150:153], v[210:213]
ds_read_b128 v[174:177], v218 offset:21504
v_mfma_f32_16x16x32_bf16 v[190:193], v[186:189], v[130:133], v[190:193]
ds_read_b64_tr_b16 v[152:153], v254 offset:1024
v_mfma_f32_16x16x32_bf16 v[194:197], v[186:189], v[142:145], v[194:197]
s_waitcnt lgkmcnt(7)
v_mfma_f32_16x16x32_bf16 v[202:205], v[178:181], v[130:133], v[202:205]
v_mfma_f32_16x16x32_bf16 v[206:209], v[178:181], v[142:145], v[206:209]
ds_read_b64_tr_b16 v[144:145], v255 offset:8
v_mfma_f32_16x16x32_bf16 v[106:109], v[158:161], v[78:81], 0
v_mfma_f32_16x16x32_bf16 v[198:201], v[186:189], v[154:157], v[198:201]
ds_read_b128 v[186:189], v218 offset:19456
v_cvt_pk_bf16_f32 v74, v190, v191
v_mfma_f32_16x16x32_bf16 v[210:213], v[178:181], v[154:157], v[210:213]
ds_read_b128 v[178:181], v218 offset:22528
v_cvt_pk_bf16_f32 v75, v192, v193
v_mfma_f32_16x16x32_bf16 v[54:57], v[110:113], v[90:93], 0
ds_read_b64_tr_b16 v[156:157], v255 offset:1024
v_cvt_pk_bf16_f32 v86, v194, v195
v_mfma_f32_16x16x32_bf16 v[102:105], v[126:129], v[70:73], v[102:105]
v_cvt_pk_bf16_f32 v87, v196, v197
v_cvt_pk_bf16_f32 v76, v202, v203
v_mfma_f32_16x16x32_bf16 v[106:109], v[162:165], v[82:85], v[106:109]
v_cvt_pk_bf16_f32 v77, v204, v205
v_cvt_pk_bf16_f32 v88, v206, v207
v_mfma_f32_16x16x32_bf16 v[54:57], v[114:117], v[94:97], v[54:57]
v_cvt_pk_bf16_f32 v89, v208, v209
v_cvt_pk_bf16_f32 v98, v198, v199
v_mfma_f32_16x16x32_bf16 v[102:105], v[130:133], v[74:77], v[102:105]
v_cvt_pk_bf16_f32 v99, v200, v201
v_cvt_pk_bf16_f32 v100, v210, v211
v_mfma_f32_16x16x32_bf16 v[106:109], v[166:169], v[86:89], v[106:109]
v_cvt_pk_bf16_f32 v101, v212, v213
s_waitcnt lgkmcnt(6)
v_mfma_f32_16x16x32_bf16 v[190:193], v[122:125], v[182:185], 0
v_mfma_f32_16x16x32_bf16 v[194:197], v[158:161], v[182:185], 0
v_mfma_f32_16x16x32_bf16 v[54:57], v[118:121], v[98:101], v[54:57]
v_mfma_f32_16x16x32_bf16 v[198:201], v[110:113], v[182:185], 0
ds_read_b128 v[182:185], v218 offset:23552
s_waitcnt lgkmcnt(3)
v_mfma_f32_16x16x32_bf16 v[190:193], v[126:129], v[186:189], v[190:193]
v_mfma_f32_16x16x32_bf16 v[194:197], v[162:165], v[186:189], v[194:197]
v_cndmask_b32_e64 v102, v102, v106, s[86:87]
v_cndmask_b32_e64 v103, v103, v107, s[86:87]
v_mfma_f32_16x16x32_bf16 v[198:201], v[114:117], v[186:189], v[198:201]
ds_read_b128 v[186:189], v218 offset:24576
v_cndmask_b32_e64 v104, v104, v108, s[86:87]
v_mfma_f32_16x16x32_bf16 v[190:193], v[130:133], v[170:173], v[190:193]
v_cndmask_b32_e64 v102, v102, v54, s[88:89]
v_cndmask_b32_e64 v103, v103, v55, s[88:89]
v_mfma_f32_16x16x32_bf16 v[194:197], v[166:169], v[170:173], v[194:197]
v_cndmask_b32_e64 v104, v104, v56, s[88:89]
v_cndmask_b32_e64 v105, v105, v109, s[86:87]
v_mfma_f32_16x16x32_bf16 v[198:201], v[118:121], v[170:173], v[198:201]
ds_read_b128 v[170:173], v218 offset:25600
v_mul_f32_dpp v102, v247, v102 quad_perm:[0,0,0,0] row_mask:0xf bank_mask:0xf
v_mfma_f32_16x16x32_bf16 v[202:205], v[122:125], v[174:177], 0
v_mul_f32_dpp v103, v247, v103 quad_perm:[1,1,1,1] row_mask:0xf bank_mask:0xf
v_mul_f32_dpp v104, v247, v104 quad_perm:[2,2,2,2] row_mask:0xf bank_mask:0xf
v_mfma_f32_16x16x32_bf16 v[206:209], v[158:161], v[174:177], 0
v_cndmask_b32_e64 v105, v105, v57, s[88:89]
v_max3_f32 v222, v102, v103, v104
v_mfma_f32_16x16x32_bf16 v[210:213], v[110:113], v[174:177], 0
ds_read_b128 v[174:177], v218 offset:26624
v_mul_f32_dpp v105, v247, v105 quad_perm:[3,3,3,3] row_mask:0xf bank_mask:0xf
s_waitcnt lgkmcnt(5)
v_mfma_f32_16x16x32_bf16 v[202:205], v[126:129], v[178:181], v[202:205]
v_max_f32_e32 v222, v222, v105
v_mul_f32_e64 v222, -v222, v247
v_mfma_f32_16x16x32_bf16 v[206:209], v[162:165], v[178:181], v[206:209]
v_fma_f32 v102, v102, v247, v222
v_fma_f32 v103, v103, v247, v222
v_mfma_f32_16x16x32_bf16 v[210:213], v[114:117], v[178:181], v[210:213]
ds_read_b128 v[178:181], v218 offset:27648
v_fma_f32 v104, v104, v247, v222
s_waitcnt lgkmcnt(4)
v_mfma_f32_16x16x32_bf16 v[202:205], v[130:133], v[182:185], v[202:205]
v_fma_f32 v105, v105, v247, v222
v_exp_f32_e32 v102, v102
v_mfma_f32_16x16x32_bf16 v[206:209], v[166:169], v[182:185], v[206:209]
v_exp_f32_e32 v103, v103
v_mfma_f32_16x16x32_bf16 v[210:213], v[118:121], v[182:185], v[210:213]
ds_read_b128 v[182:185], v218 offset:28672
v_exp_f32_e32 v104, v104
v_exp_f32_e32 v105, v105
v_add_f32_e32 v222, v102, v103
v_add_f32_e32 v225, v104, v105
v_add_f32_e32 v225, v225, v222
v_rcp_f32_e32 v225, v225
v_mul_f32_dpp v102, v247, v102 quad_perm:[0,0,0,0] row_mask:0xf bank_mask:0xf
v_mul_f32_dpp v103, v247, v103 quad_perm:[1,1,1,1] row_mask:0xf bank_mask:0xf
v_mul_f32_dpp v104, v247, v104 quad_perm:[2,2,2,2] row_mask:0xf bank_mask:0xf
v_mul_f32_dpp v105, v247, v105 quad_perm:[3,3,3,3] row_mask:0xf bank_mask:0xf
v_mul_f32_e32 v102, v102, v225
v_mul_f32_e32 v103, v103, v225
v_mul_f32_e32 v104, v104, v225
v_mul_f32_e32 v105, v105, v225
v_cvt_pk_bf16_f32 v222, v102, v103
v_cvt_pk_bf16_f32 v225, v104, v105
v_cvt_pk_bf16_f32 v58, v190, v191
v_cvt_pk_bf16_f32 v59, v192, v193
s_waitcnt lgkmcnt(4)
v_mfma_f32_16x16x32_bf16 v[190:193], v[122:125], v[186:189], 0
v_cvt_pk_bf16_f32 v226, v194, v195
v_cvt_pk_bf16_f32 v227, v196, v197
v_mfma_f32_16x16x32_bf16 v[194:197], v[158:161], v[186:189], 0
v_cvt_pk_bf16_f32 v230, v198, v199
v_cvt_pk_bf16_f32 v231, v200, v201
v_mfma_f32_16x16x32_bf16 v[198:201], v[110:113], v[186:189], 0
ds_read_b128 v[186:189], v218 offset:29696
v_cvt_pk_bf16_f32 v134, v202, v203
s_waitcnt lgkmcnt(4)
v_mfma_f32_16x16x32_bf16 v[190:193], v[126:129], v[170:173], v[190:193]
v_cvt_pk_bf16_f32 v135, v204, v205
v_cvt_pk_bf16_f32 v138, v206, v207
v_mfma_f32_16x16x32_bf16 v[194:197], v[162:165], v[170:173], v[194:197]
v_cvt_pk_bf16_f32 v139, v208, v209
v_cvt_pk_bf16_f32 v142, v210, v211
v_mfma_f32_16x16x32_bf16 v[198:201], v[114:117], v[170:173], v[198:201]
ds_read_b128 v[170:173], v218 offset:30720
v_cvt_pk_bf16_f32 v143, v212, v213
s_waitcnt lgkmcnt(4)
v_mfma_f32_16x16x32_bf16 v[190:193], v[130:133], v[174:177], v[190:193]
v_cndmask_b32_e64 v102, 0, v222, s[40:41]
v_cndmask_b32_e64 v103, 0, v225, s[40:41]
v_mfma_f32_16x16x32_bf16 v[194:197], v[166:169], v[174:177], v[194:197]
v_mov_b32_e32 v104, v236
v_mov_b32_e32 v105, v237
v_mfma_f32_16x16x32_bf16 v[198:201], v[118:121], v[174:177], v[198:201]
ds_read_b128 v[174:177], v218 offset:31744
v_cndmask_b32_e64 v106, 0, v222, s[86:87]
s_waitcnt lgkmcnt(4)
v_mfma_f32_16x16x32_bf16 v[202:205], v[122:125], v[178:181], 0
v_cvt_pk_bf16_f32 v146, v190, v191
ds_read_b64_tr_b16 v[20:21], v250 offset:1032
v_mfma_f32_16x16x32_bf16 v[206:209], v[158:161], v[178:181], 0
v_cvt_pk_bf16_f32 v147, v192, v193
v_cvt_pk_bf16_f32 v150, v194, v195
ds_read_b64_tr_b16 v[24:25], v254 offset:1032
v_mfma_f32_16x16x32_bf16 v[210:213], v[110:113], v[178:181], 0
ds_read_b128 v[178:181], v218 offset:32768
v_cvt_pk_bf16_f32 v151, v196, v197
s_waitcnt lgkmcnt(6)
v_mfma_f32_16x16x32_bf16 v[202:205], v[126:129], v[182:185], v[202:205]
v_cvt_pk_bf16_f32 v154, v198, v199
ds_read_b64_tr_b16 v[28:29], v255 offset:1032
v_mfma_f32_16x16x32_bf16 v[206:209], v[162:165], v[182:185], v[206:209]
v_cvt_pk_bf16_f32 v155, v200, v201
v_cndmask_b32_e64 v107, 0, v225, s[86:87]
v_mfma_f32_16x16x32_bf16 v[210:213], v[114:117], v[182:185], v[210:213]
ds_read_b128 v[182:185], v218 offset:33792
v_mov_b32_e32 v108, v236
s_waitcnt lgkmcnt(6)
v_mfma_f32_16x16x32_bf16 v[190:193], v[122:125], v[170:173], 0
v_mov_b32_e32 v109, v237
v_cndmask_b32_e64 v54, 0, v222, s[88:89]
v_mfma_f32_16x16x32_bf16 v[202:205], v[130:133], v[186:189], v[202:205]
v_cndmask_b32_e64 v55, 0, v225, s[88:89]
v_mov_b32_e32 v56, v236
v_mfma_f32_16x16x32_bf16 v[206:209], v[166:169], v[186:189], v[206:209]
v_mov_b32_e32 v57, v237
v_mfma_f32_16x16x32_bf16 v[210:213], v[118:121], v[186:189], v[210:213]
ds_read_b128 v[186:189], v218 offset:34816
s_waitcnt lgkmcnt(6)
v_mfma_f32_16x16x32_bf16 v[190:193], v[126:129], v[174:177], v[190:193]
v_mfma_f32_16x16x32_bf16 v[194:197], v[158:161], v[170:173], 0
v_cvt_pk_bf16_f32 v18, v202, v203
ds_read_b64_tr_b16 v[32:33], v250 offset:2048
v_mfma_f32_16x16x32_bf16 v[198:201], v[110:113], v[170:173], 0
ds_read_b128 v[170:173], v218 offset:35840
v_cvt_pk_bf16_f32 v22, v206, v207
s_setprio 1
s_waitcnt lgkmcnt(5)
v_mfma_f32_16x16x32_bf16 v[190:193], v[130:133], v[178:181], v[190:193]
ds_read_b64_tr_b16 v[36:37], v254 offset:2048
v_cvt_pk_bf16_f32 v23, v208, v209
v_mfma_f32_16x16x32_bf16 v[194:197], v[162:165], v[174:177], v[194:197]
v_cvt_pk_bf16_f32 v19, v204, v205
v_cvt_pk_bf16_f32 v26, v210, v211
ds_read_b64_tr_b16 v[40:41], v255 offset:2048
v_mfma_f32_16x16x32_bf16 v[194:197], v[166:169], v[178:181], v[194:197]
v_cvt_pk_bf16_f32 v27, v212, v213
v_cvt_pk_bf16_f32 v30, v190, v191
ds_read_b64_tr_b16 v[44:45], v250 offset:2056
v_mfma_f32_16x16x32_bf16 v[198:201], v[114:117], v[174:177], v[198:201]
ds_read_b128 v[174:177], v4 offset:1024
v_cvt_pk_bf16_f32 v31, v192, v193
s_waitcnt lgkmcnt(7)
v_mfma_f32_16x16x32_bf16 v[206:209], v[158:161], v[182:185], 0
v_mfma_f32_16x16x32_bf16 v[202:205], v[122:125], v[182:185], 0
v_cvt_pk_bf16_f32 v34, v194, v195
ds_read_b64_tr_b16 v[48:49], v254 offset:2056
v_mfma_f32_16x16x32_bf16 v[210:213], v[110:113], v[182:185], 0
ds_read_b128 v[182:185], v4 offset:3072
v_cvt_pk_bf16_f32 v35, v196, v197
v_mfma_f32_16x16x32_bf16 v[198:201], v[118:121], v[178:181], v[198:201]
ds_read_b128 v[178:181], v4 offset:2048
s_waitcnt lgkmcnt(9)
v_mfma_f32_16x16x32_bf16 v[206:209], v[162:165], v[186:189], v[206:209]
v_mfma_f32_16x16x32_bf16 v[202:205], v[126:129], v[186:189], v[202:205]
v_mfma_f32_16x16x32_bf16 v[210:213], v[114:117], v[186:189], v[210:213]
ds_read_b128 v[186:189], v4 offset:4096
s_waitcnt lgkmcnt(8)
v_mfma_f32_16x16x32_bf16 v[206:209], v[166:169], v[170:173], v[206:209]
v_mfma_f32_16x16x32_bf16 v[202:205], v[130:133], v[170:173], v[202:205]
v_mfma_f32_16x16x32_bf16 v[210:213], v[118:121], v[170:173], v[210:213]
ds_read_b128 v[170:173], v4 offset:0
v_cvt_pk_bf16_f32 v38, v198, v199
v_mfma_f32_16x16x32_bf16 v[190:193], v[58:61], v[102:105], 0
ds_read_b64_tr_b16 v[52:53], v255 offset:2056
v_cvt_pk_bf16_f32 v39, v200, v201
v_mfma_f32_16x16x32_bf16 v[194:197], v[134:137], v[102:105], 0
v_cvt_pk_bf16_f32 v46, v206, v207
v_cvt_pk_bf16_f32 v47, v208, v209
v_mfma_f32_16x16x32_bf16 v[198:201], v[146:149], v[102:105], 0
v_cvt_pk_bf16_f32 v42, v202, v203
v_cvt_pk_bf16_f32 v43, v204, v205
v_mfma_f32_16x16x32_bf16 v[206:209], v[30:33], v[102:105], 0
v_cvt_pk_bf16_f32 v50, v210, v211
v_cvt_pk_bf16_f32 v51, v212, v213
v_mfma_f32_16x16x32_bf16 v[202:205], v[18:21], v[102:105], 0
v_cvt_pk_bf16_f32 v66, v190, v191
v_cvt_pk_bf16_f32 v67, v192, v193
s_waitcnt lgkmcnt(7)
v_mfma_f32_16x16x32_bf16 v[210:213], v[42:45], v[102:105], 0
v_cvt_pk_bf16_f32 v68, v194, v195
v_cvt_pk_bf16_f32 v69, v196, v197
ds_write_b128 v5, v[66:69] offset:0
v_mfma_f32_16x16x32_bf16 v[190:193], v[226:229], v[106:109], 0
v_cvt_pk_bf16_f32 v70, v198, v199
v_cvt_pk_bf16_f32 v71, v200, v201
v_mfma_f32_16x16x32_bf16 v[194:197], v[138:141], v[106:109], 0
v_cvt_pk_bf16_f32 v74, v206, v207
v_cvt_pk_bf16_f32 v75, v208, v209
v_mfma_f32_16x16x32_bf16 v[198:201], v[150:153], v[106:109], 0
v_cvt_pk_bf16_f32 v72, v202, v203
v_cvt_pk_bf16_f32 v73, v204, v205
ds_write_b128 v5, v[70:73] offset:1024
v_mfma_f32_16x16x32_bf16 v[206:209], v[34:37], v[106:109], 0
v_cvt_pk_bf16_f32 v76, v210, v211
v_cvt_pk_bf16_f32 v77, v212, v213
ds_write_b128 v5, v[74:77] offset:2048
v_mfma_f32_16x16x32_bf16 v[202:205], v[22:25], v[106:109], 0
v_cvt_pk_bf16_f32 v78, v190, v191
v_cvt_pk_bf16_f32 v79, v192, v193
s_waitcnt lgkmcnt(8)
v_mfma_f32_16x16x32_bf16 v[210:213], v[46:49], v[106:109], 0
v_cvt_pk_bf16_f32 v80, v194, v195
v_cvt_pk_bf16_f32 v81, v196, v197
ds_write_b128 v6, v[78:81] offset:0
v_mfma_f32_16x16x32_bf16 v[190:193], v[230:233], v[54:57], 0
v_cvt_pk_bf16_f32 v82, v198, v199
v_cvt_pk_bf16_f32 v83, v200, v201
v_mfma_f32_16x16x32_bf16 v[194:197], v[142:145], v[54:57], 0
v_cvt_pk_bf16_f32 v86, v206, v207
v_cvt_pk_bf16_f32 v87, v208, v209
v_mfma_f32_16x16x32_bf16 v[198:201], v[154:157], v[54:57], 0
v_cvt_pk_bf16_f32 v84, v202, v203
v_cvt_pk_bf16_f32 v85, v204, v205
ds_write_b128 v6, v[82:85] offset:1024
v_mfma_f32_16x16x32_bf16 v[206:209], v[38:41], v[54:57], 0
v_cvt_pk_bf16_f32 v88, v210, v211
v_cvt_pk_bf16_f32 v89, v212, v213
ds_write_b128 v6, v[86:89] offset:2048
v_mfma_f32_16x16x32_bf16 v[202:205], v[26:29], v[54:57], 0
v_cvt_pk_bf16_f32 v90, v190, v191
v_cvt_pk_bf16_f32 v91, v192, v193
s_waitcnt lgkmcnt(6)
v_mfma_f32_16x16x32_bf16 v[210:213], v[50:53], v[54:57], 0
v_cvt_pk_bf16_f32 v92, v194, v195
v_cvt_pk_bf16_f32 v93, v196, v197
ds_write_b128 v7, v[90:93] offset:0
v_mfma_f32_16x16x32_bf16 v[190:193], v[66:69], v[66:69], 0
v_cvt_pk_bf16_f32 v94, v198, v199
v_cvt_pk_bf16_f32 v95, v200, v201
v_mfma_f32_16x16x32_bf16 v[198:201], v[78:81], v[78:81], 0
v_cvt_pk_bf16_f32 v98, v206, v207
v_cvt_pk_bf16_f32 v99, v208, v209
v_mfma_f32_16x16x32_bf16 v[206:209], v[90:93], v[90:93], 0
v_cvt_pk_bf16_f32 v96, v202, v203
v_cvt_pk_bf16_f32 v97, v204, v205
ds_write_b128 v7, v[94:97] offset:1024
v_mfma_f32_16x16x32_bf16 v[194:197], v[214:217], v[66:69], 0
v_cvt_pk_bf16_f32 v100, v210, v211
v_cvt_pk_bf16_f32 v101, v212, v213
ds_write_b128 v7, v[98:101] offset:2048
v_mfma_f32_16x16x32_bf16 v[202:205], v[214:217], v[78:81], 0
v_mfma_f32_16x16x32_bf16 v[210:213], v[214:217], v[90:93], 0
v_mfma_f32_16x16x32_bf16 v[190:193], v[70:73], v[70:73], v[190:193]
s_setprio 0
v_mfma_f32_16x16x32_bf16 v[198:201], v[82:85], v[82:85], v[198:201]
v_mfma_f32_16x16x32_bf16 v[206:209], v[94:97], v[94:97], v[206:209]
v_mfma_f32_16x16x32_bf16 v[194:197], v[214:217], v[70:73], v[194:197]
v_mfma_f32_16x16x32_bf16 v[202:205], v[214:217], v[82:85], v[202:205]
v_mfma_f32_16x16x32_bf16 v[210:213], v[214:217], v[94:97], v[210:213]
v_mfma_f32_16x16x32_bf16 v[190:193], v[74:77], v[74:77], v[190:193]
v_mfma_f32_16x16x32_bf16 v[198:201], v[86:89], v[86:89], v[198:201]
v_mfma_f32_16x16x32_bf16 v[206:209], v[98:101], v[98:101], v[206:209]
v_mfma_f32_16x16x32_bf16 v[194:197], v[214:217], v[74:77], v[194:197]
v_mfma_f32_16x16x32_bf16 v[202:205], v[214:217], v[86:89], v[202:205]
v_mfma_f32_16x16x32_bf16 v[210:213], v[214:217], v[98:101], v[210:213]
s_nop 2
v_cndmask_b32_e64 v248, v190, v191, s[42:43]
v_cndmask_b32_e64 v248, v248, v192, s[44:45]
v_cndmask_b32_e64 v248, v248, v193, s[46:47]
v_cndmask_b32_e64 v249, v198, v199, s[42:43]
v_cndmask_b32_e64 v249, v249, v200, s[44:45]
v_cndmask_b32_e64 v251, v206, v207, s[42:43]
v_mul_f32_e32 v219, v194, v194
v_cndmask_b32_e64 v251, v251, v208, s[44:45]
v_cndmask_b32_e64 v249, v249, v201, s[46:47]
v_mul_f32_e32 v220, v202, v202
v_fma_f32 v248, v219, s55, v248
v_cndmask_b32_e64 v251, v251, v209, s[46:47]
v_mul_f32_e32 v221, v210, v210
v_fma_f32 v249, v220, s55, v249
v_max_f32_e32 v248, 0, v248
v_fma_f32 v251, v221, s55, v251
v_max_f32_e32 v249, 0, v249
v_add_f32_e32 v248, 0x3a7ba882, v248
v_max_f32_e32 v251, 0, v251
v_add_f32_e32 v249, 0x3a7ba882, v249
v_rsq_f32_e32 v219, v248
v_add_f32_e32 v251, 0x3a7ba882, v251
ds_write_b32 v8, v219 offset:0
v_rsq_f32_e32 v220, v249
v_rsq_f32_e32 v221, v251
v_mul_f32_e32 v248, v248, v219
v_mul_f32_e32 v249, v249, v220
v_cvt_pk_bf16_f32 v248, v248, v248
ds_write_b16 v9, v248 offset:0
ds_write_b32 v8, v220 offset:16
v_mul_f32_e32 v251, v251, v221
v_cvt_pk_bf16_f32 v249, v249, v249
ds_write_b16 v9, v249 offset:8
ds_write_b32 v8, v221 offset:32
v_cvt_pk_bf16_f32 v251, v251, v251
ds_write_b16 v9, v251 offset:16
s_waitcnt lgkmcnt(0)

s_barrier
s_setprio 3

s_cmp_lg_u32 s48, 0
s_cbranch_scc1 L_exok
s_mov_b32 m0, s36
s_add_u32 s52, s52, 4096
s_mov_b32 exec_hi, 0x3ffff
buffer_load_dwordx4 v4, s[12:15], s52 offen lds
s_mov_b32 exec_hi, -1
s_waitcnt vmcnt(0)
L_exok:
ds_read_b128 v[18:21], v10 offset:0
v_mov_b32_e32 v163, 0
ds_read_b128 v[30:33], v10 offset:3072
ds_read_b128 v[42:45], v10 offset:6144
ds_read_b128 v[102:105], v14 offset:0
ds_read_b128 v[22:25], v10 offset:1024
ds_read_b128 v[34:37], v10 offset:4096
s_waitcnt lgkmcnt(5)
v_mfma_f32_16x16x32_bf16 v[202:205], v[170:173], v[18:21], 0
ds_read_b128 v[46:49], v10 offset:7168
s_waitcnt lgkmcnt(5)
v_mfma_f32_16x16x32_bf16 v[206:209], v[170:173], v[30:33], 0
ds_read_b128 v[106:109], v14 offset:64
s_waitcnt lgkmcnt(5)
v_mfma_f32_16x16x32_bf16 v[210:213], v[170:173], v[42:45], 0
s_add_u32 m0, s53, 0
s_nop 0
buffer_load_dwordx4 v0, s[4:7], s51 offen offset:0 nt lds
s_waitcnt lgkmcnt(3)
s_add_u32 m0, s53, 960
s_nop 0
buffer_load_dwordx4 v0, s[4:7], s51 offen offset:64 nt lds
ds_read_b128 v[26:29], v10 offset:2048
s_waitcnt lgkmcnt(0)
s_add_u32 m0, s53, 1920
s_nop 0
buffer_load_dwordx4 v0, s[4:7], s51 offen offset:128 nt lds
v_mfma_f32_16x16x32_bf16 v[190:193], v[102:105], v[18:21], 0
ds_read_b128 v[38:41], v10 offset:5120
v_mfma_f32_16x16x32_bf16 v[194:197], v[102:105], v[30:33], 0
ds_read_b128 v[50:53], v10 offset:8192
v_mfma_f32_16x16x32_bf16 v[198:201], v[102:105], v[42:45], 0
ds_read_b128 v[110:113], v14 offset:128
v_mfma_f32_16x16x32_bf16 v[202:205], v[174:177], v[22:25], v[202:205]
ds_read_b128 v[232:235], v16 offset:768
v_mfma_f32_16x16x32_bf16 v[206:209], v[174:177], v[34:37], v[206:209]
ds_read_b32 v244, v12 offset:0
v_mfma_f32_16x16x32_bf16 v[190:193], v[106:109], v[22:25], v[190:193]
ds_read_b32 v245, v12 offset:64
v_mfma_f32_16x16x32_bf16 v[194:197], v[106:109], v[34:37], v[194:197]
ds_read_b32 v246, v12 offset:128
v_mfma_f32_16x16x32_bf16 v[198:201], v[106:109], v[46:49], v[198:201]
ds_read_b128 v[170:173], v4 offset:5120
v_mfma_f32_16x16x32_bf16 v[210:213], v[174:177], v[46:49], v[210:213]
ds_read_b128 v[174:177], v4 offset:6144
s_waitcnt lgkmcnt(6)
v_mfma_f32_16x16x32_bf16 v[190:193], v[110:113], v[26:29], v[190:193]
ds_read_b128 v[214:217], v11 offset:0
v_mfma_f32_16x16x32_bf16 v[194:197], v[110:113], v[38:41], v[194:197]
ds_read_b128 v[218:221], v11 offset:64
v_mfma_f32_16x16x32_bf16 v[198:201], v[110:113], v[50:53], v[198:201]
ds_read_b128 v[222:225], v11 offset:128
v_mfma_f32_16x16x32_bf16 v[202:205], v[178:181], v[26:29], v[202:205]
ds_read_b32 v104, v15 offset:640
v_mfma_f32_16x16x32_bf16 v[206:209], v[178:181], v[38:41], v[206:209]
ds_read_b32 v112, v15 offset:704
s_waitcnt lgkmcnt(10)
v_mul_f32_e32 v126, v190, v234
ds_read_b64 v[226:227], v13 offset:0
v_mfma_f32_16x16x32_bf16 v[210:213], v[178:181], v[50:53], v[210:213]
ds_read_b128 v[178:181], v4 offset:7168
s_waitcnt lgkmcnt(11)
v_mul_f32_e32 v164, v191, v244
v_mfma_f32_16x16x32_bf16 v[190:193], v[182:185], v[18:21], 0
ds_read_b64 v[228:229], v13 offset:32
v_mul_f32_e32 v140, v194, v234
s_waitcnt lgkmcnt(11)
v_mul_f32_e32 v165, v195, v245
ds_read_b64 v[230:231], v13 offset:64
v_mfma_f32_16x16x32_bf16 v[194:197], v[182:185], v[30:33], 0
v_mul_f32_e32 v154, v198, v234
s_waitcnt lgkmcnt(11)
v_mul_f32_e32 v166, v199, v246
v_mfma_f32_16x16x32_bf16 v[198:201], v[182:185], v[42:45], 0
ds_read_b128 v[182:185], v4 offset:8192
v_cvt_pk_bf16_f32 v66, v202, v203
v_mfma_f32_16x16x32_bf16 v[190:193], v[186:189], v[22:25], v[190:193]
v_cvt_pk_bf16_f32 v67, v204, v205
v_cvt_pk_bf16_f32 v78, v206, v207
v_mfma_f32_16x16x32_bf16 v[194:197], v[186:189], v[34:37], v[194:197]
v_cvt_pk_bf16_f32 v79, v208, v209
v_cvt_pk_bf16_f32 v90, v210, v211
v_mfma_f32_16x16x32_bf16 v[198:201], v[186:189], v[46:49], v[198:201]
ds_read_b128 v[186:189], v4 offset:9216
v_cvt_pk_bf16_f32 v91, v212, v213
s_waitcnt lgkmcnt(12)
v_mfma_f32_16x16x32_bf16 v[190:193], v[170:173], v[26:29], v[190:193]
v_max3_f32 v168, v164, v165, v166
v_max_f32_e32 v168, v168, v233
v_mfma_f32_16x16x32_bf16 v[194:197], v[170:173], v[38:41], v[194:197]
v_mfma_f32_16x16x32_bf16 v[198:201], v[170:173], v[50:53], v[198:201]
ds_read_b128 v[170:173], v4 offset:10240
v_max_f32_dpp v168, v168, v168 row_ror:8 row_mask:0xf bank_mask:0xf
s_waitcnt lgkmcnt(12)
v_mfma_f32_16x16x32_bf16 v[202:205], v[174:177], v[18:21], 0
v_mfma_f32_16x16x32_bf16 v[206:209], v[174:177], v[30:33], 0
v_cvt_pk_bf16_f32 v68, v190, v191
v_cvt_pk_bf16_f32 v69, v192, v193
v_mfma_f32_16x16x32_bf16 v[210:213], v[174:177], v[42:45], 0
ds_read_b128 v[174:177], v4 offset:11264
v_cvt_pk_bf16_f32 v80, v194, v195
s_waitcnt lgkmcnt(6)
v_mfma_f32_16x16x32_bf16 v[202:205], v[178:181], v[22:25], v[202:205]
v_cvt_pk_bf16_f32 v81, v196, v197
v_cvt_pk_bf16_f32 v92, v198, v199
v_mfma_f32_16x16x32_bf16 v[206:209], v[178:181], v[34:37], v[206:209]
v_cvt_pk_bf16_f32 v93, v200, v201
v_max_f32_dpp v168, v168, v168 row_ror:4 row_mask:0xf bank_mask:0xf
v_mfma_f32_16x16x32_bf16 v[210:213], v[178:181], v[46:49], v[210:213]
ds_read_b128 v[178:181], v4 offset:12288
v_max_f32_dpp v168, v168, v168 row_ror:2 row_mask:0xf bank_mask:0xf
s_waitcnt lgkmcnt(3)
v_mfma_f32_16x16x32_bf16 v[190:193], v[186:189], v[18:21], 0
v_mfma_f32_16x16x32_bf16 v[194:197], v[186:189], v[30:33], 0
v_max_f32_dpp v168, v168, v168 row_ror:1 row_mask:0xf bank_mask:0xf
v_mul_f32_e64 v168, -v168, v234
v_mfma_f32_16x16x32_bf16 v[198:201], v[186:189], v[42:45], 0
ds_read_b128 v[186:189], v4 offset:14336
v_fma_f32 v164, v164, v234, v168
v_mfma_f32_16x16x32_bf16 v[202:205], v[182:185], v[26:29], v[202:205]
v_fma_f32 v165, v165, v234, v168
v_exp_f32_e32 v164, v164
v_mfma_f32_16x16x32_bf16 v[206:209], v[182:185], v[38:41], v[206:209]
v_exp_f32_e32 v165, v165
v_mfma_f32_16x16x32_bf16 v[210:213], v[182:185], v[50:53], v[210:213]
ds_read_b128 v[182:185], v4 offset:13312
v_fma_f32 v166, v166, v234, v168
s_waitcnt lgkmcnt(4)
v_mfma_f32_16x16x32_bf16 v[190:193], v[170:173], v[22:25], v[190:193]
v_cvt_pk_bf16_f32 v70, v202, v203
v_cvt_pk_bf16_f32 v71, v204, v205
v_mfma_f32_16x16x32_bf16 v[194:197], v[170:173], v[34:37], v[194:197]
v_cvt_pk_bf16_f32 v82, v206, v207
v_cvt_pk_bf16_f32 v83, v208, v209
v_mfma_f32_16x16x32_bf16 v[198:201], v[170:173], v[46:49], v[198:201]
ds_read_b128 v[170:173], v4 offset:15360
v_cvt_pk_bf16_f32 v94, v210, v211
s_waitcnt lgkmcnt(4)
v_mfma_f32_16x16x32_bf16 v[190:193], v[174:177], v[26:29], v[190:193]
v_cvt_pk_bf16_f32 v95, v212, v213
v_exp_f32_e32 v166, v166
v_mfma_f32_16x16x32_bf16 v[194:197], v[174:177], v[38:41], v[194:197]
v_add_f32_e32 v169, v164, v165
v_add_f32_e32 v169, v169, v166
v_mfma_f32_16x16x32_bf16 v[198:201], v[174:177], v[50:53], v[198:201]
ds_read_b128 v[174:177], v4 offset:16384
v_add_f32_dpp v169, v169, v169 row_ror:8 row_mask:0xf bank_mask:0xf
s_waitcnt lgkmcnt(4)
v_mfma_f32_16x16x32_bf16 v[202:205], v[178:181], v[18:21], 0
v_cvt_pk_bf16_f32 v72, v190, v191
v_cvt_pk_bf16_f32 v73, v192, v193
v_mfma_f32_16x16x32_bf16 v[206:209], v[178:181], v[30:33], 0
v_cvt_pk_bf16_f32 v84, v194, v195
v_cvt_pk_bf16_f32 v85, v196, v197
v_mfma_f32_16x16x32_bf16 v[210:213], v[178:181], v[42:45], 0
ds_read_b128 v[178:181], v4 offset:17408
v_cvt_pk_bf16_f32 v96, v198, v199
s_waitcnt lgkmcnt(3)
v_mfma_f32_16x16x32_bf16 v[202:205], v[182:185], v[22:25], v[202:205]
v_cvt_pk_bf16_f32 v97, v200, v201
v_fma_f32 v167, v233, v234, v168
v_mfma_f32_16x16x32_bf16 v[206:209], v[182:185], v[34:37], v[206:209]
v_add_f32_dpp v169, v169, v169 row_ror:4 row_mask:0xf bank_mask:0xf
v_exp_f32_e32 v167, v167
v_mfma_f32_16x16x32_bf16 v[210:213], v[182:185], v[46:49], v[210:213]
ds_read_b128 v[182:185], v4 offset:18432
v_add_f32_dpp v169, v169, v169 row_ror:2 row_mask:0xf bank_mask:0xf
s_waitcnt lgkmcnt(3)
v_mfma_f32_16x16x32_bf16 v[190:193], v[170:173], v[18:21], 0
v_mul_f32_e32 v164, v164, v244
v_add_f32_dpp v169, v169, v169 row_ror:1 row_mask:0xf bank_mask:0xf
v_mfma_f32_16x16x32_bf16 v[202:205], v[186:189], v[26:29], v[202:205]
v_add_f32_e32 v169, v169, v167
v_rcp_f32_e32 v169, v169
v_mfma_f32_16x16x32_bf16 v[206:209], v[186:189], v[38:41], v[206:209]
v_mul_f32_e32 v165, v165, v245
v_mul_f32_e32 v164, v164, v169
v_mfma_f32_16x16x32_bf16 v[210:213], v[186:189], v[50:53], v[210:213]
ds_read_b128 v[186:189], v4 offset:19456
v_mul_f32_e32 v165, v165, v169
s_waitcnt lgkmcnt(3)
v_mfma_f32_16x16x32_bf16 v[190:193], v[174:177], v[22:25], v[190:193]
v_cvt_pk_bf16_f32 v74, v202, v203
v_cvt_pk_bf16_f32 v75, v204, v205
v_mfma_f32_16x16x32_bf16 v[194:197], v[170:173], v[30:33], 0
v_cvt_pk_bf16_f32 v86, v206, v207
v_cvt_pk_bf16_f32 v87, v208, v209
v_mfma_f32_16x16x32_bf16 v[198:201], v[170:173], v[42:45], 0
ds_read_b128 v[170:173], v4 offset:20480
v_cvt_pk_bf16_f32 v98, v210, v211
s_waitcnt lgkmcnt(3)
v_mfma_f32_16x16x32_bf16 v[190:193], v[178:181], v[26:29], v[190:193]
v_cvt_pk_bf16_f32 v99, v212, v213
v_cvt_pk_bf16_f32 v164, v164, v165
ds_write_b16 v62, v164 offset:832
ds_write_b16_d16_hi v62, v164 offset:864
ds_read_b64 v[156:157], v63 offset:832
v_mfma_f32_16x16x32_bf16 v[194:197], v[174:177], v[34:37], v[194:197]
ds_read_b64 v[158:159], v63 offset:864
v_mul_f32_e32 v166, v166, v246
v_mfma_f32_16x16x32_bf16 v[198:201], v[174:177], v[46:49], v[198:201]
ds_read_b128 v[174:177], v4 offset:21504
v_cvt_pk_bf16_f32 v76, v190, v191
v_mfma_f32_16x16x32_bf16 v[202:205], v[18:21], v[66:69], 0
v_cvt_pk_bf16_f32 v77, v192, v193
v_mul_f32_e32 v166, v166, v169
v_mfma_f32_16x16x32_bf16 v[206:209], v[30:33], v[66:69], 0
s_add_u32 m0, s53, 3072
s_nop 0
buffer_load_dwordx4 v1, s[4:7], s51 offen offset:0 nt lds
s_add_u32 m0, s53, 4032
s_nop 0
buffer_load_dwordx4 v1, s[4:7], s51 offen offset:64 nt lds
s_add_u32 m0, s53, 4992
s_nop 0
buffer_load_dwordx4 v1, s[4:7], s51 offen offset:128 nt lds
v_cvt_pk_bf16_f32 v166, v166, v166
ds_write_b16 v62, v166 offset:896
ds_read_b64 v[160:161], v63 offset:896
v_mfma_f32_16x16x32_bf16 v[210:213], v[42:45], v[66:69], 0
v_mul_f32_e32 v167, v167, v234
v_mul_f32_e32 v167, v167, v169
v_mfma_f32_16x16x32_bf16 v[194:197], v[178:181], v[38:41], v[194:197]
v_cvt_pk_bf16_f32 v167, v167, 1.0
v_cndmask_b32_e64 v162, 0, v167, s[38:39]
v_mfma_f32_16x16x32_bf16 v[198:201], v[178:181], v[50:53], v[198:201]
ds_read_b128 v[178:181], v4 offset:22528
v_mfma_f32_16x16x32_bf16 v[202:205], v[22:25], v[70:73], v[202:205]
v_mfma_f32_16x16x32_bf16 v[206:209], v[34:37], v[70:73], v[206:209]
v_mfma_f32_16x16x32_bf16 v[210:213], v[46:49], v[70:73], v[210:213]
ds_read_b32 v72, v15 offset:384
v_cvt_pk_bf16_f32 v88, v194, v195
v_mfma_f32_16x16x32_bf16 v[202:205], v[26:29], v[74:77], v[202:205]
v_cvt_pk_bf16_f32 v89, v196, v197
v_cvt_pk_bf16_f32 v100, v198, v199
v_mfma_f32_16x16x32_bf16 v[206:209], v[38:41], v[74:77], v[206:209]
v_cvt_pk_bf16_f32 v101, v200, v201
v_mfma_f32_16x16x32_bf16 v[210:213], v[50:53], v[74:77], v[210:213]
v_mfma_f32_16x16x32_bf16 v[190:193], v[18:21], v[78:81], 0
v_mfma_f32_16x16x32_bf16 v[194:197], v[30:33], v[78:81], 0
v_mfma_f32_16x16x32_bf16 v[198:201], v[42:45], v[78:81], 0
ds_read_b32 v80, v15 offset:448
v_mul_f32_e32 v114, v202, v214
v_mfma_f32_16x16x32_bf16 v[190:193], v[22:25], v[82:85], v[190:193]
v_mul_f32_e32 v115, v203, v215
v_mul_f32_e32 v116, v204, v216
v_mfma_f32_16x16x32_bf16 v[194:197], v[34:37], v[82:85], v[194:197]
v_mul_f32_e32 v117, v205, v217
v_mul_f32_e32 v118, v206, v218
v_mfma_f32_16x16x32_bf16 v[198:201], v[46:49], v[82:85], v[198:201]
v_mul_f32_e32 v119, v207, v219
v_mul_f32_e32 v120, v208, v220
v_mfma_f32_16x16x32_bf16 v[202:205], v[18:21], v[90:93], 0
v_mul_f32_e32 v121, v209, v221
v_mul_f32_e32 v122, v210, v222
v_mfma_f32_16x16x32_bf16 v[206:209], v[30:33], v[90:93], 0
v_mul_f32_e32 v123, v211, v223
v_mul_f32_e32 v124, v212, v224
v_mfma_f32_16x16x32_bf16 v[190:193], v[26:29], v[86:89], v[190:193]
v_mul_f32_e32 v125, v213, v225
v_max3_f32 v247, v114, v115, v116
v_mfma_f32_16x16x32_bf16 v[210:213], v[42:45], v[90:93], 0
v_max3_f32 v251, v117, v118, v119
v_max3_f32 v247, v247, v120, v121
v_mfma_f32_16x16x32_bf16 v[194:197], v[38:41], v[86:89], v[194:197]
v_max3_f32 v251, v251, v122, v123
v_max3_f32 v247, v247, v124, v125
v_mfma_f32_16x16x32_bf16 v[198:201], v[50:53], v[86:89], v[198:201]
ds_read_b32 v88, v15 offset:512
v_mul_f32_e32 v128, v190, v214
v_mfma_f32_16x16x32_bf16 v[202:205], v[22:25], v[94:97], v[202:205]
v_mul_f32_e32 v129, v191, v215
v_mul_f32_e32 v130, v192, v216
v_mfma_f32_16x16x32_bf16 v[206:209], v[34:37], v[94:97], v[206:209]
v_mul_f32_e32 v131, v193, v217
v_mul_f32_e32 v132, v194, v218
v_mfma_f32_16x16x32_bf16 v[210:213], v[46:49], v[94:97], v[210:213]
ds_read_b32 v96, v15 offset:576
v_mul_f32_e32 v133, v195, v219
s_waitcnt lgkmcnt(14)
v_mfma_f32_16x16x32_bf16 v[190:193], v[18:21], v[182:185], 0
v_mul_f32_e32 v134, v196, v220
v_mul_f32_e32 v135, v197, v221
v_mfma_f32_16x16x32_bf16 v[194:197], v[30:33], v[182:185], 0
v_mul_f32_e32 v136, v198, v222
v_mul_f32_e32 v137, v199, v223
s_waitcnt lgkmcnt(13)
v_mfma_f32_16x16x32_bf16 v[190:193], v[22:25], v[186:189], v[190:193]
v_mul_f32_e32 v138, v200, v224
v_mul_f32_e32 v139, v201, v225
v_mfma_f32_16x16x32_bf16 v[198:201], v[42:45], v[182:185], 0
ds_read_b128 v[182:185], v4 offset:23552
v_max3_f32 v247, v247, v251, v126
v_mfma_f32_16x16x32_bf16 v[194:197], v[34:37], v[186:189], v[194:197]
ds_swizzle_b32 v251, v247 offset:0x401f
v_max3_f32 v248, v128, v129, v130
v_mfma_f32_16x16x32_bf16 v[198:201], v[46:49], v[186:189], v[198:201]
s_setprio 2
s_waitcnt lgkmcnt(2)
s_mov_b32 m0, s36
s_add_u32 s52, s52, 4096
s_mov_b32 exec_hi, 0x3ffff
buffer_load_dwordx4 v4, s[12:15], s52 offen lds
s_mov_b32 exec_hi, -1
ds_read_b128 v[186:189], v4 offset:24576
v_max3_f32 v252, v131, v132, v133
v_mfma_f32_16x16x32_bf16 v[202:205], v[26:29], v[98:101], v[202:205]
v_max3_f32 v248, v248, v134, v135
v_max3_f32 v252, v252, v136, v137
v_mfma_f32_16x16x32_bf16 v[206:209], v[38:41], v[98:101], v[206:209]
v_max3_f32 v248, v248, v138, v139
v_max3_f32 v248, v248, v252, v140
ds_swizzle_b32 v252, v248 offset:0x401f
v_mfma_f32_16x16x32_bf16 v[210:213], v[50:53], v[98:101], v[210:213]
v_mfma_f32_16x16x32_bf16 v[190:193], v[26:29], v[170:173], v[190:193]
v_mul_f32_e32 v142, v202, v214
v_mul_f32_e32 v143, v203, v215
v_mfma_f32_16x16x32_bf16 v[194:197], v[38:41], v[170:173], v[194:197]
v_mul_f32_e32 v144, v204, v216
v_mul_f32_e32 v145, v205, v217
v_mfma_f32_16x16x32_bf16 v[198:201], v[50:53], v[170:173], v[198:201]
ds_read_b128 v[170:173], v4 offset:25600
v_mul_f32_e32 v146, v206, v218
v_mfma_f32_16x16x32_bf16 v[202:205], v[18:21], v[174:177], 0
v_mul_f32_e32 v147, v207, v219
v_mul_f32_e32 v148, v208, v220
v_mfma_f32_16x16x32_bf16 v[202:205], v[22:25], v[178:181], v[202:205]
v_mul_f32_e32 v149, v209, v221
v_mul_f32_e32 v150, v210, v222
v_mfma_f32_16x16x32_bf16 v[206:209], v[30:33], v[174:177], 0
v_mul_f32_e32 v151, v211, v223
v_mul_f32_e32 v152, v212, v224
v_mfma_f32_16x16x32_bf16 v[206:209], v[34:37], v[178:181], v[206:209]
v_mul_f32_e32 v153, v213, v225
v_cvt_pk_bf16_f32 v66, v190, v191
v_mfma_f32_16x16x32_bf16 v[210:213], v[42:45], v[174:177], 0
ds_read_b128 v[174:177], v4 offset:26624
v_cvt_pk_bf16_f32 v67, v192, v193
s_waitcnt lgkmcnt(5)
v_mfma_f32_16x16x32_bf16 v[202:205], v[26:29], v[182:185], v[202:205]
v_cvt_pk_bf16_f32 v68, v194, v195
v_cvt_pk_bf16_f32 v69, v196, v197
v_mfma_f32_16x16x32_bf16 v[210:213], v[46:49], v[178:181], v[210:213]
ds_read_b128 v[178:181], v4 offset:27648
v_cvt_pk_bf16_f32 v70, v198, v199
v_mfma_f32_16x16x32_bf16 v[206:209], v[38:41], v[182:185], v[206:209]
v_cvt_pk_bf16_f32 v71, v200, v201
s_waitcnt lgkmcnt(5)
v_max_f32_e32 v247, v247, v251
ds_bpermute_b32 v251, v17, v247
v_mfma_f32_16x16x32_bf16 v[210:213], v[50:53], v[182:185], v[210:213]
ds_read_b128 v[182:185], v4 offset:28672
v_cvt_pk_bf16_f32 v74, v202, v203
s_waitcnt lgkmcnt(6)
v_mfma_f32_16x16x32_bf16 v[190:193], v[18:21], v[186:189], 0
v_cvt_pk_bf16_f32 v75, v204, v205
v_cvt_pk_bf16_f32 v76, v206, v207
v_mfma_f32_16x16x32_bf16 v[194:197], v[30:33], v[186:189], 0
v_cvt_pk_bf16_f32 v77, v208, v209
v_max3_f32 v249, v142, v143, v144
v_mfma_f32_16x16x32_bf16 v[198:201], v[42:45], v[186:189], 0
ds_read_b128 v[186:189], v4 offset:29696
v_cvt_pk_bf16_f32 v78, v210, v211
s_waitcnt lgkmcnt(5)
v_mfma_f32_16x16x32_bf16 v[190:193], v[22:25], v[170:173], v[190:193]
v_cvt_pk_bf16_f32 v79, v212, v213
v_max3_f32 v253, v145, v146, v147
v_mfma_f32_16x16x32_bf16 v[194:197], v[34:37], v[170:173], v[194:197]
v_max3_f32 v249, v249, v148, v149
v_max3_f32 v253, v253, v150, v151
v_mfma_f32_16x16x32_bf16 v[198:201], v[46:49], v[170:173], v[198:201]
ds_read_b128 v[170:173], v4 offset:30720
v_max3_f32 v249, v249, v152, v153
s_waitcnt lgkmcnt(4)
v_mfma_f32_16x16x32_bf16 v[202:205], v[18:21], v[178:181], 0
v_max3_f32 v249, v249, v253, v154
ds_swizzle_b32 v253, v249 offset:0x401f
v_mfma_f32_16x16x32_bf16 v[206:209], v[30:33], v[178:181], 0
v_max_f32_e32 v248, v248, v252
ds_bpermute_b32 v252, v17, v248
v_mfma_f32_16x16x32_bf16 v[210:213], v[42:45], v[178:181], 0
ds_read_b128 v[178:181], v4 offset:32768
s_waitcnt lgkmcnt(6)
v_max_f32_e32 v247, v247, v251
v_mfma_f32_16x16x32_bf16 v[190:193], v[26:29], v[174:177], v[190:193]
v_mul_f32_e64 v247, -v247, v244
v_fma_f32 v114, v114, v244, v247
v_mfma_f32_16x16x32_bf16 v[194:197], v[38:41], v[174:177], v[194:197]
v_fma_f32 v115, v115, v244, v247
v_fma_f32 v116, v116, v244, v247
v_mfma_f32_16x16x32_bf16 v[198:201], v[50:53], v[174:177], v[198:201]
ds_read_b128 v[174:177], v4 offset:31744
v_fma_f32 v117, v117, v244, v247
s_waitcnt lgkmcnt(6)
v_mfma_f32_16x16x32_bf16 v[202:205], v[22:25], v[182:185], v[202:205]
v_cvt_pk_bf16_f32 v82, v190, v191
v_cvt_pk_bf16_f32 v83, v192, v193
v_mfma_f32_16x16x32_bf16 v[206:209], v[34:37], v[182:185], v[206:209]
v_cvt_pk_bf16_f32 v84, v194, v195
v_cvt_pk_bf16_f32 v85, v196, v197
v_mfma_f32_16x16x32_bf16 v[210:213], v[46:49], v[182:185], v[210:213]
ds_read_b128 v[182:185], v4 offset:33792
v_cvt_pk_bf16_f32 v86, v198, v199
s_waitcnt lgkmcnt(6)
v_mfma_f32_16x16x32_bf16 v[202:205], v[26:29], v[186:189], v[202:205]
v_cvt_pk_bf16_f32 v87, v200, v201
v_fma_f32 v118, v118, v244, v247
s_add_u32 m0, s53, 6144
s_nop 0
buffer_load_dwordx4 v2, s[4:7], s51 offen offset:0 nt lds
s_add_u32 m0, s53, 7104
s_nop 0
buffer_load_dwordx4 v2, s[4:7], s51 offen offset:64 nt lds
s_add_u32 m0, s53, 8064
s_nop 0
buffer_load_dwordx4 v2, s[4:7], s51 offen offset:128 nt lds
v_mfma_f32_16x16x32_bf16 v[206:209], v[38:41], v[186:189], v[206:209]
v_fma_f32 v119, v119, v244, v247
v_fma_f32 v120, v120, v244, v247
v_mfma_f32_16x16x32_bf16 v[210:213], v[50:53], v[186:189], v[210:213]
ds_read_b128 v[186:189], v4 offset:34816
v_fma_f32 v121, v121, v244, v247
s_waitcnt lgkmcnt(6)
v_mfma_f32_16x16x32_bf16 v[190:193], v[18:21], v[170:173], 0
v_cvt_pk_bf16_f32 v90, v202, v203
v_cvt_pk_bf16_f32 v91, v204, v205
v_mfma_f32_16x16x32_bf16 v[194:197], v[30:33], v[170:173], 0
v_cvt_pk_bf16_f32 v92, v206, v207
v_cvt_pk_bf16_f32 v93, v208, v209
v_mfma_f32_16x16x32_bf16 v[198:201], v[42:45], v[170:173], 0
ds_read_b128 v[170:173], v4 offset:35840
v_cvt_pk_bf16_f32 v94, v210, v211
s_waitcnt lgkmcnt(3)
v_mfma_f32_16x16x32_bf16 v[194:197], v[34:37], v[174:177], v[194:197]
v_cvt_pk_bf16_f32 v95, v212, v213
v_exp_f32_e32 v114, v114
s_waitcnt lgkmcnt(2)
v_mfma_f32_16x16x32_bf16 v[202:205], v[18:21], v[182:185], 0
v_exp_f32_e32 v115, v115
v_mfma_f32_16x16x32_bf16 v[190:193], v[22:25], v[174:177], v[190:193]
v_exp_f32_e32 v116, v116
v_mfma_f32_16x16x32_bf16 v[194:197], v[38:41], v[178:181], v[194:197]
v_exp_f32_e32 v117, v117
v_mfma_f32_16x16x32_bf16 v[206:209], v[30:33], v[182:185], 0
v_fma_f32 v122, v122, v244, v247
v_fma_f32 v123, v123, v244, v247
s_waitcnt lgkmcnt(1)
v_mfma_f32_16x16x32_bf16 v[202:205], v[22:25], v[186:189], v[202:205]
v_fma_f32 v124, v124, v244, v247
v_fma_f32 v125, v125, v244, v247
v_mfma_f32_16x16x32_bf16 v[210:213], v[42:45], v[182:185], 0
v_cvt_pk_bf16_f32 v100, v194, v195
v_cvt_pk_bf16_f32 v101, v196, v197
v_mfma_f32_16x16x32_bf16 v[198:201], v[46:49], v[174:177], v[198:201]
v_exp_f32_e32 v118, v118
v_mfma_f32_16x16x32_bf16 v[190:193], v[26:29], v[178:181], v[190:193]
v_exp_f32_e32 v119, v119
v_mfma_f32_16x16x32_bf16 v[206:209], v[34:37], v[186:189], v[206:209]
v_exp_f32_e32 v120, v120
s_waitcnt lgkmcnt(0)
v_mfma_f32_16x16x32_bf16 v[202:205], v[26:29], v[170:173], v[202:205]
v_exp_f32_e32 v121, v121
v_mfma_f32_16x16x32_bf16 v[210:213], v[46:49], v[186:189], v[210:213]
v_subrev_u32_e32 v186, 36864, v4
ds_read_b128 v[174:177], v186 offset:1024
v_mfma_f32_16x16x32_bf16 v[198:201], v[50:53], v[178:181], v[198:201]
v_cvt_pk_bf16_f32 v98, v190, v191
ds_read_b128 v[178:181], v186 offset:2048
v_mfma_f32_16x16x32_bf16 v[194:197], v[74:77], v[156:159], 0
v_cvt_pk_bf16_f32 v99, v192, v193
ds_read_b128 v[182:185], v186 offset:3072
v_mfma_f32_16x16x32_bf16 v[206:209], v[38:41], v[170:173], v[206:209]
v_cvt_pk_bf16_f32 v106, v202, v203
v_cvt_pk_bf16_f32 v107, v204, v205
v_mfma_f32_16x16x32_bf16 v[210:213], v[50:53], v[170:173], v[210:213]
ds_read_b128 v[170:173], v186 offset:0
v_cvt_pk_bf16_f32 v102, v198, v199
v_mfma_f32_16x16x32_bf16 v[190:193], v[66:69], v[156:159], 0
ds_read_b128 v[186:189], v186 offset:4096
v_cvt_pk_bf16_f32 v103, v200, v201
v_mfma_f32_16x16x32_bf16 v[194:197], v[78:81], v[160:163], v[194:197]
v_exp_f32_e32 v122, v122
v_mfma_f32_16x16x32_bf16 v[202:205], v[90:93], v[156:159], 0
v_exp_f32_e32 v123, v123
v_mfma_f32_16x16x32_bf16 v[190:193], v[70:73], v[160:163], v[190:193]
v_exp_f32_e32 v124, v124
v_mfma_f32_16x16x32_bf16 v[198:201], v[82:85], v[156:159], 0
v_exp_f32_e32 v125, v125
v_mfma_f32_16x16x32_bf16 v[202:205], v[94:97], v[160:163], v[202:205]
v_mul_f32_e32 v114, v114, v214
v_mul_f32_e32 v115, v115, v215
v_mfma_f32_16x16x32_bf16 v[198:201], v[86:89], v[160:163], v[198:201]
v_mul_f32_e32 v116, v116, v216
v_mul_f32_e32 v117, v117, v217
v_cvt_pk_bf16_f32 v108, v206, v207
v_cvt_pk_bf16_f32 v109, v208, v209
v_mfma_f32_16x16x32_bf16 v[206:209], v[98:101], v[156:159], 0
v_mul_f32_e32 v118, v118, v218
v_mul_f32_e32 v119, v119, v219
v_mfma_f32_16x16x32_bf16 v[206:209], v[102:105], v[160:163], v[206:209]
v_mul_f32_e32 v120, v120, v220
v_mul_f32_e32 v121, v121, v221
v_cvt_pk_bf16_f32 v114, v114, v115
v_cvt_pk_bf16_f32 v110, v210, v211
v_cvt_pk_bf16_f32 v111, v212, v213
v_mfma_f32_16x16x32_bf16 v[210:213], v[106:109], v[156:159], 0
v_mul_f32_e32 v122, v122, v222
v_mul_f32_e32 v123, v123, v223
v_mfma_f32_16x16x32_bf16 v[210:213], v[110:113], v[160:163], v[210:213]
v_mul_f32_e32 v124, v124, v224
v_mul_f32_e32 v125, v125, v225
v_cvt_pk_bf16_f32 v115, v116, v117
v_fma_f32 v126, v126, v244, v247
v_cvt_pk_bf16_f32 v116, v118, v119
v_cvt_pk_bf16_f32 v117, v120, v121
v_cvt_pk_bf16_f32 v118, v122, v123
v_cvt_pk_bf16_f32 v119, v124, v125
v_mfma_f32_16x16x32_bf16 v[122:125], v[226:229], v[114:117], 0
v_exp_f32_e32 v126, v126
v_cvt_pk_bf16_f32 v56, v194, v195
v_cvt_pk_bf16_f32 v57, v196, v197
v_mfma_f32_16x16x32_bf16 v[194:197], v[74:77], v[114:117], 0
v_mul_f32_e32 v126, v126, v235
v_cvt_pk_bf16_f32 v54, v190, v191
v_cvt_pk_bf16_f32 v55, v192, v193
buffer_store_dwordx4 v[54:57], v3, s[8:11], s50 offen offset:0
v_mfma_f32_16x16x32_bf16 v[190:193], v[66:69], v[114:117], 0
v_cvt_pk_bf16_f32 v120, v126, 0
v_mov_b32_e32 v121, 0
v_cvt_pk_bf16_f32 v60, v202, v203
v_cvt_pk_bf16_f32 v61, v204, v205
v_mfma_f32_16x16x32_bf16 v[122:125], v[230:233], v[118:121], v[122:125]
v_cvt_pk_bf16_f32 v58, v198, v199
v_cvt_pk_bf16_f32 v59, v200, v201
buffer_store_dwordx4 v[58:61], v3, s[8:11], s50 offen offset:64
v_mfma_f32_16x16x32_bf16 v[202:205], v[240:243], v[18:21], 0
v_cvt_pk_bf16_f32 v56, v210, v211
v_cvt_pk_bf16_f32 v57, v212, v213
v_mfma_f32_16x16x32_bf16 v[194:197], v[78:81], v[118:121], v[194:197]
v_max_f32_e32 v249, v249, v253
ds_bpermute_b32 v253, v17, v249
v_mfma_f32_16x16x32_bf16 v[198:201], v[236:239], v[18:21], 0
v_cvt_pk_bf16_f32 v54, v206, v207
s_setprio 1
v_cvt_pk_bf16_f32 v55, v208, v209
buffer_store_dwordx4 v[54:57], v3, s[8:11], s50 offen offset:128
v_mfma_f32_16x16x32_bf16 v[190:193], v[70:73], v[118:121], v[190:193]
v_rcp_f32_e32 v247, v122
v_mfma_f32_16x16x32_bf16 v[210:213], v[90:93], v[114:117], 0
v_fma_f32 v194, v194, v247, v202
v_fma_f32 v195, v195, v247, v203
v_mfma_f32_16x16x32_bf16 v[206:209], v[82:85], v[114:117], 0
v_fma_f32 v196, v196, v247, v204
v_fma_f32 v197, v197, v247, v205
v_mfma_f32_16x16x32_bf16 v[122:125], v[240:243], v[22:25], 0
v_max_f32_e32 v248, v248, v252
v_fma_f32 v190, v190, v247, v198
v_mfma_f32_16x16x32_bf16 v[210:213], v[94:97], v[118:121], v[210:213]
v_fma_f32 v191, v191, v247, v199
v_fma_f32 v192, v192, v247, v200
v_mfma_f32_16x16x32_bf16 v[206:209], v[86:89], v[118:121], v[206:209]
v_fma_f32 v193, v193, v247, v201
v_cvt_pk_bf16_f32 v20, v194, v195
v_mfma_f32_16x16x32_bf16 v[202:205], v[236:239], v[26:29], 0
v_cvt_pk_bf16_f32 v21, v196, v197
v_mul_f32_e64 v248, -v248, v245
v_mfma_f32_16x16x32_bf16 v[194:197], v[98:101], v[114:117], 0
v_cvt_pk_bf16_f32 v18, v190, v191
v_cvt_pk_bf16_f32 v19, v192, v193
buffer_store_dwordx4 v[18:21], v0, s[8:11], s50 offen offset:0
v_mfma_f32_16x16x32_bf16 v[190:193], v[236:239], v[22:25], 0
v_fma_f32 v128, v128, v245, v248
v_fma_f32 v129, v129, v245, v248
v_mfma_f32_16x16x32_bf16 v[194:197], v[102:105], v[118:121], v[194:197]
v_fma_f32 v130, v130, v245, v248
v_fma_f32 v131, v131, v245, v248
v_mfma_f32_16x16x32_bf16 v[198:201], v[106:109], v[114:117], 0
v_fma_f32 v132, v132, v245, v248
v_fma_f32 v133, v133, v245, v248
v_mfma_f32_16x16x32_bf16 v[198:201], v[110:113], v[118:121], v[198:201]
v_fma_f32 v134, v134, v245, v248
v_fma_f32 v135, v135, v245, v248
v_exp_f32_e32 v128, v128
v_exp_f32_e32 v129, v129
v_exp_f32_e32 v130, v130
v_exp_f32_e32 v131, v131
v_fma_f32 v136, v136, v245, v248
v_fma_f32 v137, v137, v245, v248
v_fma_f32 v138, v138, v245, v248
v_fma_f32 v139, v139, v245, v248
v_exp_f32_e32 v132, v132
v_exp_f32_e32 v133, v133
v_exp_f32_e32 v134, v134
v_exp_f32_e32 v135, v135
v_exp_f32_e32 v136, v136
v_exp_f32_e32 v137, v137
v_exp_f32_e32 v138, v138
v_exp_f32_e32 v139, v139
v_mul_f32_e32 v128, v128, v214
v_mul_f32_e32 v129, v129, v215
v_mul_f32_e32 v130, v130, v216
v_mul_f32_e32 v131, v131, v217
v_mul_f32_e32 v132, v132, v218
v_mul_f32_e32 v133, v133, v219
v_mul_f32_e32 v134, v134, v220
v_mul_f32_e32 v135, v135, v221
v_cvt_pk_bf16_f32 v128, v128, v129
v_mul_f32_e32 v136, v136, v222
v_mul_f32_e32 v137, v137, v223
v_mul_f32_e32 v138, v138, v224
v_mul_f32_e32 v139, v139, v225
v_cvt_pk_bf16_f32 v129, v130, v131
v_fma_f32 v140, v140, v245, v248
v_cvt_pk_bf16_f32 v130, v132, v133
v_cvt_pk_bf16_f32 v131, v134, v135
v_cvt_pk_bf16_f32 v132, v136, v137
v_cvt_pk_bf16_f32 v133, v138, v139
v_mfma_f32_16x16x32_bf16 v[136:139], v[226:229], v[128:131], 0
v_exp_f32_e32 v140, v140
v_fma_f32 v210, v210, v247, v122
v_fma_f32 v211, v211, v247, v123
v_fma_f32 v212, v212, v247, v124
v_fma_f32 v213, v213, v247, v125
v_mfma_f32_16x16x32_bf16 v[122:125], v[240:243], v[26:29], 0
v_fma_f32 v206, v206, v247, v190
v_fma_f32 v207, v207, v247, v191
v_fma_f32 v208, v208, v247, v192
v_fma_f32 v209, v209, v247, v193
v_mfma_f32_16x16x32_bf16 v[190:193], v[236:239], v[30:33], 0
v_cvt_pk_bf16_f32 v24, v210, v211
v_cvt_pk_bf16_f32 v25, v212, v213
v_mfma_f32_16x16x32_bf16 v[210:213], v[74:77], v[128:131], 0
v_mul_f32_e32 v140, v140, v235
v_cvt_pk_bf16_f32 v22, v206, v207
v_cvt_pk_bf16_f32 v23, v208, v209
buffer_store_dwordx4 v[22:25], v0, s[8:11], s50 offen offset:64
v_mfma_f32_16x16x32_bf16 v[206:209], v[66:69], v[128:131], 0
v_cvt_pk_bf16_f32 v134, v140, 0
v_mov_b32_e32 v135, 0
v_fma_f32 v194, v194, v247, v202
v_fma_f32 v195, v195, v247, v203
v_mfma_f32_16x16x32_bf16 v[136:139], v[230:233], v[132:135], v[136:139]
v_fma_f32 v196, v196, v247, v204
v_fma_f32 v197, v197, v247, v205
v_mfma_f32_16x16x32_bf16 v[210:213], v[78:81], v[132:135], v[210:213]
v_cvt_pk_bf16_f32 v26, v194, v195
v_cvt_pk_bf16_f32 v27, v196, v197
v_mfma_f32_16x16x32_bf16 v[194:197], v[240:243], v[30:33], 0
v_fma_f32 v198, v198, v247, v122
v_fma_f32 v199, v199, v247, v123
v_mfma_f32_16x16x32_bf16 v[206:209], v[70:73], v[132:135], v[206:209]
v_fma_f32 v200, v200, v247, v124
v_fma_f32 v201, v201, v247, v125
v_mfma_f32_16x16x32_bf16 v[202:205], v[90:93], v[128:131], 0
v_cvt_pk_bf16_f32 v28, v198, v199
v_cvt_pk_bf16_f32 v29, v200, v201
buffer_store_dwordx4 v[26:29], v0, s[8:11], s50 offen offset:128
v_mfma_f32_16x16x32_bf16 v[198:201], v[82:85], v[128:131], 0
v_rcp_f32_e32 v248, v136
v_mfma_f32_16x16x32_bf16 v[136:139], v[240:243], v[34:37], 0
s_waitcnt lgkmcnt(0)
v_max_f32_e32 v249, v249, v253
v_fma_f32 v210, v210, v248, v194
v_mfma_f32_16x16x32_bf16 v[202:205], v[94:97], v[132:135], v[202:205]
v_fma_f32 v211, v211, v248, v195
v_fma_f32 v212, v212, v248, v196
v_mfma_f32_16x16x32_bf16 v[198:201], v[86:89], v[132:135], v[198:201]
v_fma_f32 v213, v213, v248, v197
v_mul_f32_e64 v249, -v249, v246
v_mfma_f32_16x16x32_bf16 v[194:197], v[236:239], v[38:41], 0
v_fma_f32 v206, v206, v248, v190
v_fma_f32 v207, v207, v248, v191
v_fma_f32 v208, v208, v248, v192
v_fma_f32 v209, v209, v248, v193
v_mfma_f32_16x16x32_bf16 v[190:193], v[106:109], v[128:131], 0
v_cvt_pk_bf16_f32 v32, v210, v211
v_cvt_pk_bf16_f32 v33, v212, v213
v_mfma_f32_16x16x32_bf16 v[210:213], v[98:101], v[128:131], 0
v_fma_f32 v142, v142, v246, v249
v_fma_f32 v143, v143, v246, v249
v_mfma_f32_16x16x32_bf16 v[210:213], v[102:105], v[132:135], v[210:213]
v_fma_f32 v144, v144, v246, v249
v_fma_f32 v145, v145, v246, v249
v_mfma_f32_16x16x32_bf16 v[190:193], v[110:113], v[132:135], v[190:193]
v_cvt_pk_bf16_f32 v30, v206, v207
v_cvt_pk_bf16_f32 v31, v208, v209
buffer_store_dwordx4 v[30:33], v1, s[8:11], s50 offen offset:0
v_mfma_f32_16x16x32_bf16 v[206:209], v[236:239], v[34:37], 0
v_fma_f32 v146, v146, v246, v249
v_fma_f32 v147, v147, v246, v249
v_fma_f32 v148, v148, v246, v249
v_fma_f32 v149, v149, v246, v249
v_exp_f32_e32 v142, v142
v_exp_f32_e32 v143, v143
v_exp_f32_e32 v144, v144
s_setprio 0
v_exp_f32_e32 v145, v145
v_fma_f32 v150, v150, v246, v249
v_fma_f32 v151, v151, v246, v249
v_fma_f32 v152, v152, v246, v249
v_fma_f32 v153, v153, v246, v249
v_exp_f32_e32 v146, v146
v_exp_f32_e32 v147, v147
v_exp_f32_e32 v148, v148
v_exp_f32_e32 v149, v149
v_exp_f32_e32 v150, v150
v_exp_f32_e32 v151, v151
v_exp_f32_e32 v152, v152
v_exp_f32_e32 v153, v153
v_mul_f32_e32 v142, v142, v214
v_mul_f32_e32 v143, v143, v215
v_mul_f32_e32 v144, v144, v216
v_mul_f32_e32 v145, v145, v217
v_mul_f32_e32 v146, v146, v218
v_mul_f32_e32 v147, v147, v219
v_mul_f32_e32 v148, v148, v220
v_mul_f32_e32 v149, v149, v221
v_cvt_pk_bf16_f32 v142, v142, v143
v_mul_f32_e32 v150, v150, v222
v_mul_f32_e32 v151, v151, v223
v_mul_f32_e32 v152, v152, v224
v_mul_f32_e32 v153, v153, v225
v_cvt_pk_bf16_f32 v143, v144, v145
v_fma_f32 v154, v154, v246, v249
v_cvt_pk_bf16_f32 v144, v146, v147
v_cvt_pk_bf16_f32 v145, v148, v149
v_cvt_pk_bf16_f32 v146, v150, v151
v_cvt_pk_bf16_f32 v147, v152, v153
v_mfma_f32_16x16x32_bf16 v[150:153], v[226:229], v[142:145], 0
v_exp_f32_e32 v154, v154
v_fma_f32 v202, v202, v248, v136
v_fma_f32 v203, v203, v248, v137
v_fma_f32 v204, v204, v248, v138
v_fma_f32 v205, v205, v248, v139
v_mfma_f32_16x16x32_bf16 v[136:139], v[240:243], v[38:41], 0
v_mul_f32_e32 v154, v154, v235
v_fma_f32 v198, v198, v248, v206
v_fma_f32 v199, v199, v248, v207
v_fma_f32 v200, v200, v248, v208
v_fma_f32 v201, v201, v248, v209
v_mfma_f32_16x16x32_bf16 v[206:209], v[236:239], v[42:45], 0
v_cvt_pk_bf16_f32 v36, v202, v203
v_cvt_pk_bf16_f32 v37, v204, v205
v_mfma_f32_16x16x32_bf16 v[202:205], v[74:77], v[142:145], 0
v_cvt_pk_bf16_f32 v148, v154, 0
v_mov_b32_e32 v149, 0
v_cvt_pk_bf16_f32 v34, v198, v199
v_cvt_pk_bf16_f32 v35, v200, v201
buffer_store_dwordx4 v[34:37], v1, s[8:11], s50 offen offset:64
v_mfma_f32_16x16x32_bf16 v[198:201], v[66:69], v[142:145], 0
v_fma_f32 v210, v210, v248, v194
v_fma_f32 v211, v211, v248, v195
v_mfma_f32_16x16x32_bf16 v[150:153], v[230:233], v[146:149], v[150:153]
v_fma_f32 v212, v212, v248, v196
v_fma_f32 v213, v213, v248, v197
v_mfma_f32_16x16x32_bf16 v[202:205], v[78:81], v[146:149], v[202:205]
v_cvt_pk_bf16_f32 v38, v210, v211
v_cvt_pk_bf16_f32 v39, v212, v213
v_mfma_f32_16x16x32_bf16 v[210:213], v[240:243], v[42:45], 0
v_fma_f32 v190, v190, v248, v136
v_fma_f32 v191, v191, v248, v137
v_mfma_f32_16x16x32_bf16 v[198:201], v[70:73], v[146:149], v[198:201]
v_rcp_f32_e32 v249, v150
v_mfma_f32_16x16x32_bf16 v[194:197], v[90:93], v[142:145], 0
v_fma_f32 v192, v192, v248, v138
v_fma_f32 v193, v193, v248, v139
v_mfma_f32_16x16x32_bf16 v[150:153], v[240:243], v[46:49], 0
v_fma_f32 v202, v202, v249, v210
v_fma_f32 v203, v203, v249, v211
v_mfma_f32_16x16x32_bf16 v[194:197], v[94:97], v[146:149], v[194:197]
v_fma_f32 v204, v204, v249, v212
v_fma_f32 v205, v205, v249, v213
v_mfma_f32_16x16x32_bf16 v[210:213], v[236:239], v[50:53], 0
s_waitcnt vmcnt(8)
s_cmp_eq_u32 s48, s54
s_cbranch_scc1 L_skipb
s_barrier
L_skipb:
s_setprio 3

v_cvt_pk_bf16_f32 v40, v190, v191
v_cvt_pk_bf16_f32 v41, v192, v193
buffer_store_dwordx4 v[38:41], v1, s[8:11], s50 offen offset:128
v_mfma_f32_16x16x32_bf16 v[190:193], v[82:85], v[142:145], 0
v_fma_f32 v198, v198, v249, v206
v_fma_f32 v199, v199, v249, v207
v_mfma_f32_16x16x32_bf16 v[190:193], v[86:89], v[146:149], v[190:193]
v_fma_f32 v200, v200, v249, v208
v_fma_f32 v201, v201, v249, v209
v_mfma_f32_16x16x32_bf16 v[206:209], v[106:109], v[142:145], 0
v_cvt_pk_bf16_f32 v44, v202, v203
v_cvt_pk_bf16_f32 v45, v204, v205
v_mfma_f32_16x16x32_bf16 v[202:205], v[98:101], v[142:145], 0
v_cvt_pk_bf16_f32 v42, v198, v199
v_cvt_pk_bf16_f32 v43, v200, v201
v_mfma_f32_16x16x32_bf16 v[198:201], v[236:239], v[46:49], 0
v_fma_f32 v194, v194, v249, v150
v_fma_f32 v195, v195, v249, v151
v_mfma_f32_16x16x32_bf16 v[202:205], v[102:105], v[146:149], v[202:205]
v_fma_f32 v196, v196, v249, v152
v_fma_f32 v197, v197, v249, v153
v_mfma_f32_16x16x32_bf16 v[150:153], v[240:243], v[50:53], 0
v_cvt_pk_bf16_f32 v48, v194, v195
v_cvt_pk_bf16_f32 v49, v196, v197
v_mfma_f32_16x16x32_bf16 v[206:209], v[110:113], v[146:149], v[206:209]
v_fma_f32 v190, v190, v249, v198
v_fma_f32 v191, v191, v249, v199
v_fma_f32 v192, v192, v249, v200
v_fma_f32 v193, v193, v249, v201
v_fma_f32 v202, v202, v249, v210
v_fma_f32 v203, v203, v249, v211
v_fma_f32 v204, v204, v249, v212
v_fma_f32 v205, v205, v249, v213
v_fma_f32 v206, v206, v249, v150
v_fma_f32 v207, v207, v249, v151
v_fma_f32 v208, v208, v249, v152
v_fma_f32 v209, v209, v249, v153
v_cvt_pk_bf16_f32 v46, v190, v191
v_cvt_pk_bf16_f32 v47, v192, v193
v_cvt_pk_bf16_f32 v50, v202, v203
v_cvt_pk_bf16_f32 v51, v204, v205
v_cvt_pk_bf16_f32 v52, v206, v207
v_cvt_pk_bf16_f32 v53, v208, v209

s_add_u32 s48, s48, 1
s_cmp_lt_u32 s48, s49
s_cbranch_scc1 L_loop
buffer_store_dwordx4 v[42:45], v2, s[8:11], s50 offen offset:0
buffer_store_dwordx4 v[46:49], v2, s[8:11], s50 offen offset:64
buffer_store_dwordx4 v[50:53], v2, s[8:11], s50 offen offset:128
L_end:
s_endpgm
.section .rodata,"a"
.p2align 6
.amdhsa_kernel standalone__video_video_swin__vision_kernel
  .amdhsa_next_free_vgpr 256
  .amdhsa_next_free_sgpr 102
  .amdhsa_accum_offset 256
  .amdhsa_group_segment_fixed_size 0
  .amdhsa_kernarg_size 64
  .amdhsa_user_sgpr_count 2
  .amdhsa_user_sgpr_kernarg_segment_ptr 1
  .amdhsa_system_sgpr_workgroup_id_x 1
.end_amdhsa_kernel
```
